```python
import torch

def _softmax(x, axis=-1):
    return torch.softmax(x, dim=axis)
def _gelu(x):
    return torch.nn.functional.gelu(x, approximate="tanh")
def _silu(x):
    return torch.nn.functional.silu(x)
def _sigmoid(x):
    return torch.sigmoid(x)
def _layernorm(x, axis=-1, eps=1e-5):
    m = x.mean(dim=axis, keepdim=True)
    v = x.var(dim=axis, keepdim=True, unbiased=False)
    return (x - m) / torch.sqrt(v + eps)
def _scatter_add(tgt, idx, src, axis=0):
    return tgt.clone().index_add_(axis, idx, src)
def _segment_sum(src, seg, n):
    out = torch.zeros((n,) + src.shape[1:], dtype=src.dtype)
    return out.index_add_(0, seg, src)
def _pad(x, pw):
    flat = tuple(v for pair in reversed(pw) for v in pair)
    return torch.nn.functional.pad(x, flat)

kernel_name = 'concat_heads__gqa_block_cached__gqa_block_cached__near_ridge'

def setup_inputs():

    _w = (lambda a: (lambda t: t.to(torch.bfloat16) if t.is_floating_point() else t)(torch.as_tensor(a)))
    def _A_setup():
        B, Sq, D = 16, 128, 576
        Hq, Hkv, Sk, Dh = 32, 16, 1024, 128
        assert Hq % Hkv == 0, (Hq, Hkv)
        return {
            "x": _w((lambda *s: torch.randn(*s, dtype=torch.bfloat16) * 0.8)(B, Sq, D)),
            "k_cache": _w((lambda *s: torch.randn(*s, dtype=torch.bfloat16) * 0.8)(B, Hkv, Sk, Dh)),
            "v_cache": _w((lambda *s: torch.randn(*s, dtype=torch.bfloat16) * 0.05)(B, Hkv, Sk, Dh)),
            "wq": _w((lambda *s: torch.randn(*s, dtype=torch.bfloat16) * 0.8)(D, Hq * Dh) * (D ** -0.5)),
            "wo": _w((lambda *s: torch.randn(*s, dtype=torch.bfloat16) * 0.05)(Hq * Dh, D) * ((Hq * Dh) ** -0.5)),
        }
    _A_in = _A_setup()

    def _B_setup():
        B, Sq, D = 16, 128, 576
        Hq, Hkv, Sk, Dh = 32, 16, 1024, 128
        assert Hq % Hkv == 0, (Hq, Hkv)
        return {
            "x": _w((lambda *s: torch.randn(*s, dtype=torch.bfloat16) * 0.8)(B, Sq, D)),
            "k_cache": _w((lambda *s: torch.randn(*s, dtype=torch.bfloat16) * 0.8)(B, Hkv, Sk, Dh)),
            "v_cache": _w((lambda *s: torch.randn(*s, dtype=torch.bfloat16) * 0.05)(B, Hkv, Sk, Dh)),
            "wq": _w((lambda *s: torch.randn(*s, dtype=torch.bfloat16) * 0.8)(D, Hq * Dh) * (D ** -0.5)),
            "wo": _w((lambda *s: torch.randn(*s, dtype=torch.bfloat16) * 0.05)(Hq * Dh, D) * ((Hq * Dh) ** -0.5)),
        }
    _B_in = _B_setup()

    return {
        "A_x": _A_in["x"],
        "A_k_cache": _A_in["k_cache"],
        "A_v_cache": _A_in["v_cache"],
        "A_wq": _A_in["wq"],
        "A_wo": _A_in["wo"],
        "B_x": _B_in["x"],
        "B_k_cache": _B_in["k_cache"],
        "B_v_cache": _B_in["v_cache"],
        "B_wq": _B_in["wq"],
        "B_wo": _B_in["wo"],
    }

def reference(A_x, A_k_cache, A_v_cache, A_wq, A_wo, B_x, B_k_cache, B_v_cache, B_wq, B_wo):
    def _A_ref(x, k_cache, v_cache, wq, wo):
        B, Sq, D = x.shape
        Hq, Dh = 32, 128
        Hkv = k_cache.shape[1]
        rep = Hq // Hkv
        q = (lambda x, *d: x.permute(*d))((x @ wq).reshape(B, Sq, Hq, Dh), 0, 2, 1, 3)
        k = (lambda x, n, axis: torch.repeat_interleave(x, n, dim=axis))(k_cache, rep, axis=1)
        v = (lambda x, n, axis: torch.repeat_interleave(x, n, dim=axis))(v_cache, rep, axis=1)
        scores = torch.einsum("bhqd,bhkd->bhqk", q, k) * (Dh ** -0.5)
        p = _softmax(scores, axis=-1)
        o = torch.einsum("bhqk,bhkd->bhqd", p, v)
        return (lambda x, *d: x.permute(*d))(o, 0, 2, 1, 3).reshape(B, Sq, Hq * Dh) @ wo

    def _B_ref(x, k_cache, v_cache, wq, wo):
        B, Sq, D = x.shape
        Hq, Dh = 32, 128
        Hkv = k_cache.shape[1]
        rep = Hq // Hkv
        q = (lambda x, *d: x.permute(*d))((x @ wq).reshape(B, Sq, Hq, Dh), 0, 2, 1, 3)
        k = (lambda x, n, axis: torch.repeat_interleave(x, n, dim=axis))(k_cache, rep, axis=1)
        v = (lambda x, n, axis: torch.repeat_interleave(x, n, dim=axis))(v_cache, rep, axis=1)
        scores = torch.einsum("bhqd,bhkd->bhqk", q, k) * (Dh ** -0.5)
        p = _softmax(scores, axis=-1)
        o = torch.einsum("bhqk,bhkd->bhqd", p, v)
        return (lambda x, *d: x.permute(*d))(o, 0, 2, 1, 3).reshape(B, Sq, Hq * Dh) @ wo

    a = _A_ref(A_x, A_k_cache, A_v_cache, A_wq, A_wo)
    b = _B_ref(B_x, B_k_cache, B_v_cache, B_wq, B_wo)
    return torch.concatenate([a, b], axis=-1)
```

```asm
; @launch kernel=concat_heads__gqa_block_cached__gqa_block_cached__near_ridge_kernel grid=(512,1,1) block=(512,1,1) lds=163840
; @launch kernel=concat_oproj_kernel grid=(256,1,1) block=(256,1,1) lds=147456
.amdgcn_target "amdgcn-amd-amdhsa--gfx950"
.text
.globl concat_heads__gqa_block_cached__gqa_block_cached__near_ridge_kernel
.p2align 8
.type concat_heads__gqa_block_cached__gqa_block_cached__near_ridge_kernel,@function
concat_heads__gqa_block_cached__gqa_block_cached__near_ridge_kernel:
    s_cmp_ge_u32 s2, 512
    s_cbranch_scc1 L1_exit
    s_load_dwordx16 s[36:51], s[0:1], 0
    s_load_dwordx4 s[52:55], s[0:1], 64
    s_load_dwordx2 s[56:57], s[0:1], 80
    s_load_dwordx2 s[58:59], s[0:1], 96
    s_and_b32 s63, s2, 7
    s_lshr_b32 s64, s2, 3
    s_lshr_b32 s61, s64, 5
    s_and_b32 s64, s64, 31
    s_and_b32 s60, s63, 1
    s_lshl_b32 s60, s60, 3
    s_and_b32 s62, s64, 7
    s_add_u32 s60, s60, s62
    s_lshr_b32 s62, s63, 1
    s_lshl_b32 s62, s62, 2
    s_lshr_b32 s64, s64, 3
    s_add_u32 s62, s62, s64
    v_mov_b32 v251, v0
    v_lshrrev_b32 v253, 6, v251
    v_and_b32 v252, 63, v251
    v_readfirstlane_b32 s34, v253
    s_mov_b32 s25, 0x3e0293ee
    s_mov_b32 s26, 0x41000000
    s_waitcnt lgkmcnt(0)
    s_cmp_eq_u32 s61, 0
    s_cselect_b32 s16, s36, s46
    s_cselect_b32 s17, s37, s47
    s_cselect_b32 s4, s38, s48
    s_cselect_b32 s5, s39, s49
    s_cselect_b32 s8, s40, s50
    s_cselect_b32 s9, s41, s51
    s_cselect_b32 s12, s42, s52
    s_cselect_b32 s13, s43, s53
    s_cselect_b32 s36, s44, s54
    s_cselect_b32 s37, s45, s55
    s_lshl_b32 s63, s62, 4
    s_add_u32 s63, s63, s60
    s_lshl_b32 s64, s63, 18
    s_add_u32 s4, s4, s64
    s_addc_u32 s5, s5, 0
    s_add_u32 s8, s8, s64
    s_addc_u32 s9, s9, 0
    s_mov_b32 s6, 262144
    s_mov_b32 s7, 0x00020000
    s_mov_b32 s10, 262144
    s_mov_b32 s11, 0x00020000
    s_mov_b32 s14, 4718592
    s_mov_b32 s15, 0x00020000
    s_mul_i32 s64, s63, 18432
    s_add_u32 s36, s36, s64
    s_addc_u32 s37, s37, 0
    s_mov_b32 s38, 18432
    s_mov_b32 s39, 0x00020000
    s_mul_i32 s64, s61, 4718592
    s_add_u32 s64, s64, 67108864
    s_add_u32 s40, s58, s64
    s_addc_u32 s41, s59, 0
    s_mov_b32 s42, 4718592
    s_mov_b32 s43, 0x00020000
    s_mul_i32 s44, s63, 4608
    v_add_u32 v144, 0, v251
    v_lshlrev_b32 v145, 4, v144
    buffer_load_dwordx4 v[128:131], v145, s[36:39], 0 offen
    v_mul_u32_u24 v145, 58255, v144
    v_lshrrev_b32 v145, 22, v145
    v_mul_u32_u24 v146, 72, v145
    v_sub_u32 v146, v144, v146
    v_mul_u32_u24 v147, 3641, v146
    v_lshrrev_b32 v147, 16, v147
    v_mul_u32_u24 v140, 18, v147
    v_sub_u32 v146, v146, v140
    v_mul_u32_u24 v145, 288, v145
    v_lshl_add_u32 v145, v146, 4, v145
    v_mul_u32_u24 v147, 1179648, v147
    v_add3_u32 v140, v145, v147, s44
    v_add_u32 v144, 512, v251
    v_lshlrev_b32 v145, 4, v144
    buffer_load_dwordx4 v[132:135], v145, s[36:39], 0 offen
    v_mul_u32_u24 v145, 58255, v144
    v_lshrrev_b32 v145, 22, v145
    v_mul_u32_u24 v146, 72, v145
    v_sub_u32 v146, v144, v146
    v_mul_u32_u24 v147, 3641, v146
    v_lshrrev_b32 v147, 16, v147
    v_mul_u32_u24 v141, 18, v147
    v_sub_u32 v146, v146, v141
    v_mul_u32_u24 v145, 288, v145
    v_lshl_add_u32 v145, v146, 4, v145
    v_mul_u32_u24 v147, 1179648, v147
    v_add3_u32 v141, v145, v147, s44
    v_add_u32 v144, 1024, v251
    v_lshlrev_b32 v145, 4, v144
    buffer_load_dwordx4 v[136:139], v145, s[36:39], 0 offen
    v_mul_u32_u24 v145, 58255, v144
    v_lshrrev_b32 v145, 22, v145
    v_mul_u32_u24 v146, 72, v145
    v_sub_u32 v146, v144, v146
    v_mul_u32_u24 v147, 3641, v146
    v_lshrrev_b32 v147, 16, v147
    v_mul_u32_u24 v142, 18, v147
    v_sub_u32 v146, v146, v142
    v_mul_u32_u24 v145, 288, v145
    v_lshl_add_u32 v145, v146, 4, v145
    v_mul_u32_u24 v147, 1179648, v147
    v_add3_u32 v142, v145, v147, s44
    v_mov_b32 v146, 0x40000000
    v_cmp_gt_u32 vcc, 1152, v144
    s_nop 1
    v_cndmask_b32 v142, v146, v142, vcc
    s_mul_i32 s64, s62, 147456
    s_add_u32 s16, s16, s64
    s_addc_u32 s17, s17, 0
    s_mov_b32 s18, 147456
    s_mov_b32 s19, 0x00020000
    s_lshr_b32 s65, s34, 2
    s_and_b32 s66, s34, 3
    s_lshl_b32 s24, s34, 10
    s_lshl_b32 s67, s61, 4
    s_add_u32 s67, s67, s62
    s_lshl_b32 s67, s67, 2
    s_add_u32 s67, s67, s66
    s_lshl_b32 s67, s67, 5
    s_lshl_b32 s68, s60, 1
    s_add_u32 s68, s68, s65
    s_add_u32 s67, s67, s68
    s_lshl_b32 s67, s67, 13
    s_add_u32 s20, s58, s67
    s_addc_u32 s21, s59, 0
    s_mov_b32 s22, 8192
    s_mov_b32 s23, 0x00020000
    v_and_b32 v243, 31, v252
    v_lshrrev_b32 v244, 5, v252
    v_and_b32 v240, 15, v252
    v_lshrrev_b32 v241, 4, v252
    v_lshrrev_b32 v238, 2, v240
    v_and_b32 v239, 3, v240
    v_and_b32 v242, 1, v241
    v_and_b32 v253, 15, v243
    v_xor_b32 v253, v253, v244
    v_lshlrev_b32 v253, 4, v253
    v_lshl_add_u32 v224, v243, 8, v253
    v_xor_b32 v225, 32, v224
    v_xor_b32 v226, 64, v224
    v_xor_b32 v227, 96, v224
    v_xor_b32 v228, 128, v224
    v_xor_b32 v229, 160, v224
    v_xor_b32 v230, 192, v224
    v_xor_b32 v231, 224, v224
    v_lshlrev_b32 v254, 6, v238
    v_lshl_add_u32 v254, v242, 5, v254
    v_lshl_add_u32 v254, v239, 3, v254
    v_lshl_add_u32 v253, v244, 2, v238
    v_lshl_add_u32 v253, v253, 8, v254
    v_add_u32 v232, 65536, v253
    v_xor_b32 v233, 64, v232
    v_xor_b32 v234, 128, v232
    v_xor_b32 v235, 192, v232
    v_lshl_add_u32 v253, v244, 4, v238
    v_lshl_add_u32 v253, v253, 9, v254
    s_lshl_b32 s69, s65, 8
    s_add_u32 s69, s69, 65536
    v_add_u32 v247, s69, v253
    v_xor_b32 v248, 64, v247
    v_xor_b32 v249, 128, v247
    v_xor_b32 v250, 192, v247
    s_lshl_b32 s69, s34, 2
    v_add_u32 v253, s69, v241
    v_and_b32 v254, 15, v253
    v_xor_b32 v254, v254, v240
    v_lshlrev_b32 v254, 4, v254
    v_lshl_add_u32 v236, v253, 8, v254
    v_lshlrev_b32 v254, 2, v241
    v_xor_b32 v254, v254, v240
    v_lshlrev_b32 v254, 4, v254
    v_lshl_add_u32 v237, v253, 8, v254
    s_lshl_b32 s69, s34, 1
    v_add_u32 v253, s69, v244
    v_and_b32 v254, 3, v253
    v_lshlrev_b32 v254, 2, v254
    v_xor_b32 v254, v254, v243
    v_lshlrev_b32 v254, 4, v254
    v_lshl_add_u32 v254, v253, 13, v254
    s_lshl_b32 s69, s60, 9
    v_add_u32 v245, s69, v254
    s_lshl_b32 s69, s34, 4
    v_lshrrev_b32 v253, 2, v252
    v_add_u32 v253, s69, v253
    v_bfe_u32 v254, v253, 2, 2
    v_and_b32 v255, 3, v252
    v_xor_b32 v254, v254, v255
    v_mul_u32_u24 v253, 1152, v253
    v_lshl_add_u32 v246, v254, 4, v253
    s_lshl_b32 s69, s66, 5
    v_add_u32 v253, s69, v243
    v_bfe_u32 v254, v253, 2, 2
    v_lshlrev_b32 v255, 1, v244
    v_xor_b32 v254, v254, v255
    v_lshlrev_b32 v254, 4, v254
    v_lshl_add_u32 v253, v253, 6, v254
    v_add_u32 v126, 131072, v253
    v_xor_b32 v127, 16, v126
    v_subrev_u32 v148, 65536, v247
    v_subrev_u32 v149, 65536, v248
    v_subrev_u32 v150, 65536, v249
    v_subrev_u32 v151, 65536, v250
    v_subrev_u32 v152, 131072, v126
    v_subrev_u32 v153, 131072, v127
    s_add_u32 m0, s24, 65536
    s_mov_b32 s32, 0
    buffer_load_dwordx4 v245, s[12:15], s32 offen lds
    s_add_u32 m0, s24, 73728
    s_mov_b32 s32, 131072
    buffer_load_dwordx4 v245, s[12:15], s32 offen lds
    s_add_u32 m0, s24, 131072
    s_mov_b32 s32, 0
    buffer_load_dwordx4 v246, s[16:19], s32 offen lds
    s_add_u32 m0, s24, 81920
    s_mov_b32 s32, 262144
    buffer_load_dwordx4 v245, s[12:15], s32 offen lds
    s_add_u32 m0, s24, 90112
    s_mov_b32 s32, 393216
    buffer_load_dwordx4 v245, s[12:15], s32 offen lds
    s_add_u32 m0, s24, 139264
    s_mov_b32 s32, 64
    buffer_load_dwordx4 v246, s[16:19], s32 offen lds
    s_add_u32 m0, s24, 98304
    s_mov_b32 s32, 524288
    buffer_load_dwordx4 v245, s[12:15], s32 offen lds
    s_add_u32 m0, s24, 106496
    s_mov_b32 s32, 655360
    buffer_load_dwordx4 v245, s[12:15], s32 offen lds
    s_add_u32 m0, s24, 147456
    s_mov_b32 s32, 128
    buffer_load_dwordx4 v246, s[16:19], s32 offen lds
    s_add_u32 m0, s24, 114688
    s_mov_b32 s32, 786432
    buffer_load_dwordx4 v245, s[12:15], s32 offen lds
    s_add_u32 m0, s24, 122880
    s_mov_b32 s32, 917504
    buffer_load_dwordx4 v245, s[12:15], s32 offen lds
    s_add_u32 m0, s24, 155648
    s_mov_b32 s32, 192
    buffer_load_dwordx4 v246, s[16:19], s32 offen lds
    s_add_u32 m0, s24, 0
    s_mov_b32 s32, 1048576
    buffer_load_dwordx4 v245, s[12:15], s32 offen lds
    s_add_u32 m0, s24, 8192
    s_mov_b32 s32, 1179648
    buffer_load_dwordx4 v245, s[12:15], s32 offen lds
    s_add_u32 m0, s24, 32768
    s_mov_b32 s32, 256
    buffer_load_dwordx4 v246, s[16:19], s32 offen lds
    s_add_u32 m0, s24, 16384
    s_mov_b32 s32, 1310720
    buffer_load_dwordx4 v245, s[12:15], s32 offen lds
    s_add_u32 m0, s24, 24576
    s_mov_b32 s32, 1441792
    buffer_load_dwordx4 v245, s[12:15], s32 offen lds
    s_add_u32 m0, s24, 40960
    s_mov_b32 s32, 320
    buffer_load_dwordx4 v246, s[16:19], s32 offen lds
    s_waitcnt vmcnt(15)
    s_barrier
    ds_read_b128 v[96:99], v126 offset:0
    ds_read_b128 v[100:103], v127 offset:0
    ds_read_b64_tr_b16 v[160:161], v247 offset:0
    ds_read_b64_tr_b16 v[162:163], v247 offset:2048
    ds_read_b64_tr_b16 v[164:165], v248 offset:0
    ds_read_b64_tr_b16 v[166:167], v248 offset:2048
    ds_read_b64_tr_b16 v[168:169], v249 offset:0
    ds_read_b64_tr_b16 v[170:171], v249 offset:2048
    ds_read_b64_tr_b16 v[172:173], v250 offset:0
    ds_read_b64_tr_b16 v[174:175], v250 offset:2048
    ds_read_b64_tr_b16 v[176:177], v247 offset:4096
    ds_read_b64_tr_b16 v[178:179], v247 offset:6144
    ds_read_b64_tr_b16 v[180:181], v248 offset:4096
    ds_read_b64_tr_b16 v[182:183], v248 offset:6144
    ds_read_b64_tr_b16 v[184:185], v249 offset:4096
    s_waitcnt lgkmcnt(13)
    ds_read_b64_tr_b16 v[186:187], v249 offset:6144
    ds_read_b64_tr_b16 v[188:189], v250 offset:4096
    s_waitcnt lgkmcnt(13)
    ds_read_b64_tr_b16 v[190:191], v250 offset:6144
    s_waitcnt vmcnt(12)
    s_waitcnt lgkmcnt(0)
    s_barrier
    v_mfma_f32_32x32x16_bf16 v[0:15], v[160:163], v[96:99], 0
    ds_read_b128 v[104:107], v126 offset:8192
    ds_read_b128 v[108:111], v127 offset:8192
    ds_read_b64_tr_b16 v[192:193], v247 offset:16384
    v_mfma_f32_32x32x16_bf16 v[16:31], v[164:167], v[96:99], 0
    ds_read_b64_tr_b16 v[194:195], v247 offset:18432
    ds_read_b64_tr_b16 v[196:197], v248 offset:16384
    ds_read_b64_tr_b16 v[198:199], v248 offset:18432
    ds_read_b64_tr_b16 v[200:201], v249 offset:16384
    v_mfma_f32_32x32x16_bf16 v[32:47], v[168:171], v[96:99], 0
    ds_read_b64_tr_b16 v[202:203], v249 offset:18432
    ds_read_b64_tr_b16 v[204:205], v250 offset:16384
    ds_read_b64_tr_b16 v[206:207], v250 offset:18432
    v_mfma_f32_32x32x16_bf16 v[48:63], v[172:175], v[96:99], 0
    ds_read_b64_tr_b16 v[208:209], v247 offset:20480
    ds_read_b64_tr_b16 v[210:211], v247 offset:22528
    ds_read_b64_tr_b16 v[212:213], v248 offset:20480
    ds_read_b64_tr_b16 v[214:215], v248 offset:22528
    v_mfma_f32_32x32x16_bf16 v[0:15], v[176:179], v[100:103], v[0:15]
    ds_read_b64_tr_b16 v[216:217], v249 offset:20480
    s_waitcnt lgkmcnt(13)
    ds_read_b64_tr_b16 v[218:219], v249 offset:22528
    ds_read_b64_tr_b16 v[220:221], v250 offset:20480
    v_mfma_f32_32x32x16_bf16 v[16:31], v[180:183], v[100:103], v[16:31]
    s_waitcnt lgkmcnt(13)
    ds_read_b64_tr_b16 v[222:223], v250 offset:22528
    s_add_u32 m0, s24, 65536
    s_mov_b32 s32, 1572864
    buffer_load_dwordx4 v245, s[12:15], s32 offen lds
    s_add_u32 m0, s24, 73728
    s_mov_b32 s32, 1703936
    buffer_load_dwordx4 v245, s[12:15], s32 offen lds
    v_mfma_f32_32x32x16_bf16 v[32:47], v[184:187], v[100:103], v[32:47]
    s_add_u32 m0, s24, 131072
    s_mov_b32 s32, 384
    buffer_load_dwordx4 v246, s[16:19], s32 offen lds
    s_add_u32 m0, s24, 49152
    s_mov_b32 s33, 0
    buffer_load_dwordx4 v236, s[4:7], s33 offen nt lds
    v_mfma_f32_32x32x16_bf16 v[48:63], v[188:191], v[100:103], v[48:63]
    s_waitcnt vmcnt(13)
    s_waitcnt lgkmcnt(0)
    s_barrier
    v_mfma_f32_32x32x16_bf16 v[0:15], v[192:195], v[104:107], v[0:15]
    ds_read_b128 v[96:99], v126 offset:16384
    ds_read_b128 v[100:103], v127 offset:16384
    ds_read_b64_tr_b16 v[160:161], v247 offset:32768
    v_mfma_f32_32x32x16_bf16 v[16:31], v[196:199], v[104:107], v[16:31]
    ds_read_b64_tr_b16 v[162:163], v247 offset:34816
    ds_read_b64_tr_b16 v[164:165], v248 offset:32768
    ds_read_b64_tr_b16 v[166:167], v248 offset:34816
    ds_read_b64_tr_b16 v[168:169], v249 offset:32768
    v_mfma_f32_32x32x16_bf16 v[32:47], v[200:203], v[104:107], v[32:47]
    ds_read_b64_tr_b16 v[170:171], v249 offset:34816
    ds_read_b64_tr_b16 v[172:173], v250 offset:32768
    ds_read_b64_tr_b16 v[174:175], v250 offset:34816
    v_mfma_f32_32x32x16_bf16 v[48:63], v[204:207], v[104:107], v[48:63]
    ds_read_b64_tr_b16 v[176:177], v247 offset:36864
    ds_read_b64_tr_b16 v[178:179], v247 offset:38912
    ds_read_b64_tr_b16 v[180:181], v248 offset:36864
    ds_read_b64_tr_b16 v[182:183], v248 offset:38912
    v_mfma_f32_32x32x16_bf16 v[0:15], v[208:211], v[108:111], v[0:15]
    ds_read_b64_tr_b16 v[184:185], v249 offset:36864
    s_waitcnt lgkmcnt(13)
    ds_read_b64_tr_b16 v[186:187], v249 offset:38912
    ds_read_b64_tr_b16 v[188:189], v250 offset:36864
    v_mfma_f32_32x32x16_bf16 v[16:31], v[212:215], v[108:111], v[16:31]
    s_waitcnt lgkmcnt(13)
    ds_read_b64_tr_b16 v[190:191], v250 offset:38912
    s_add_u32 m0, s24, 81920
    s_mov_b32 s32, 1835008
    buffer_load_dwordx4 v245, s[12:15], s32 offen lds
    s_add_u32 m0, s24, 90112
    s_mov_b32 s32, 1966080
    buffer_load_dwordx4 v245, s[12:15], s32 offen lds
    v_mfma_f32_32x32x16_bf16 v[32:47], v[216:219], v[108:111], v[32:47]
    s_add_u32 m0, s24, 139264
    s_mov_b32 s32, 448
    buffer_load_dwordx4 v246, s[16:19], s32 offen lds
    s_add_u32 m0, s24, 57344
    s_mov_b32 s33, 8192
    buffer_load_dwordx4 v236, s[4:7], s33 offen nt lds
    v_mfma_f32_32x32x16_bf16 v[48:63], v[220:223], v[108:111], v[48:63]
    s_waitcnt vmcnt(14)
    s_waitcnt lgkmcnt(0)
    s_barrier
    v_mfma_f32_32x32x16_bf16 v[0:15], v[160:163], v[96:99], v[0:15]
    ds_read_b128 v[104:107], v126 offset:24576
    ds_read_b128 v[108:111], v127 offset:24576
    ds_read_b64_tr_b16 v[192:193], v247 offset:49152
    v_mfma_f32_32x32x16_bf16 v[16:31], v[164:167], v[96:99], v[16:31]
    ds_read_b64_tr_b16 v[194:195], v247 offset:51200
    ds_read_b64_tr_b16 v[196:197], v248 offset:49152
    ds_read_b64_tr_b16 v[198:199], v248 offset:51200
    ds_read_b64_tr_b16 v[200:201], v249 offset:49152
    v_mfma_f32_32x32x16_bf16 v[32:47], v[168:171], v[96:99], v[32:47]
    ds_read_b64_tr_b16 v[202:203], v249 offset:51200
    ds_read_b64_tr_b16 v[204:205], v250 offset:49152
    ds_read_b64_tr_b16 v[206:207], v250 offset:51200
    v_mfma_f32_32x32x16_bf16 v[48:63], v[172:175], v[96:99], v[48:63]
    ds_read_b64_tr_b16 v[208:209], v247 offset:53248
    ds_read_b64_tr_b16 v[210:211], v247 offset:55296
    ds_read_b64_tr_b16 v[212:213], v248 offset:53248
    v_mfma_f32_32x32x16_bf16 v[0:15], v[176:179], v[100:103], v[0:15]
    ds_read_b64_tr_b16 v[214:215], v248 offset:55296
    ds_read_b64_tr_b16 v[216:217], v249 offset:53248
    s_waitcnt lgkmcnt(13)
    ds_read_b64_tr_b16 v[218:219], v249 offset:55296
    v_mfma_f32_32x32x16_bf16 v[16:31], v[180:183], v[100:103], v[16:31]
    ds_read_b64_tr_b16 v[220:221], v250 offset:53248
    s_waitcnt lgkmcnt(13)
    ds_read_b64_tr_b16 v[222:223], v250 offset:55296
    s_add_u32 m0, s24, 98304
    s_mov_b32 s32, 2097152
    buffer_load_dwordx4 v245, s[12:15], s32 offen lds
    s_add_u32 m0, s24, 106496
    s_mov_b32 s32, 2228224
    buffer_load_dwordx4 v245, s[12:15], s32 offen lds
    v_mfma_f32_32x32x16_bf16 v[32:47], v[184:187], v[100:103], v[32:47]
    s_add_u32 m0, s24, 147456
    s_mov_b32 s32, 512
    buffer_load_dwordx4 v246, s[16:19], s32 offen lds
    v_mfma_f32_32x32x16_bf16 v[48:63], v[188:191], v[100:103], v[48:63]
    s_waitcnt vmcnt(14)
    s_waitcnt lgkmcnt(0)
    s_barrier
    v_mfma_f32_32x32x16_bf16 v[0:15], v[192:195], v[104:107], v[0:15]
    ds_read_b128 v[96:99], v152 offset:32768
    ds_read_b128 v[100:103], v153 offset:32768
    ds_read_b64_tr_b16 v[160:161], v148 offset:0
    v_mfma_f32_32x32x16_bf16 v[16:31], v[196:199], v[104:107], v[16:31]
    ds_read_b64_tr_b16 v[162:163], v148 offset:2048
    ds_read_b64_tr_b16 v[164:165], v149 offset:0
    ds_read_b64_tr_b16 v[166:167], v149 offset:2048
    ds_read_b64_tr_b16 v[168:169], v150 offset:0
    v_mfma_f32_32x32x16_bf16 v[32:47], v[200:203], v[104:107], v[32:47]
    ds_read_b64_tr_b16 v[170:171], v150 offset:2048
    ds_read_b64_tr_b16 v[172:173], v151 offset:0
    ds_read_b64_tr_b16 v[174:175], v151 offset:2048
    v_mfma_f32_32x32x16_bf16 v[48:63], v[204:207], v[104:107], v[48:63]
    ds_read_b64_tr_b16 v[176:177], v148 offset:4096
    ds_read_b64_tr_b16 v[178:179], v148 offset:6144
    ds_read_b64_tr_b16 v[180:181], v149 offset:4096
    v_mfma_f32_32x32x16_bf16 v[0:15], v[208:211], v[108:111], v[0:15]
    ds_read_b64_tr_b16 v[182:183], v149 offset:6144
    ds_read_b64_tr_b16 v[184:185], v150 offset:4096
    s_waitcnt lgkmcnt(13)
    ds_read_b64_tr_b16 v[186:187], v150 offset:6144
    v_mfma_f32_32x32x16_bf16 v[16:31], v[212:215], v[108:111], v[16:31]
    ds_read_b64_tr_b16 v[188:189], v151 offset:4096
    s_waitcnt lgkmcnt(13)
    ds_read_b64_tr_b16 v[190:191], v151 offset:6144
    s_add_u32 m0, s24, 114688
    s_mov_b32 s32, 2359296
    buffer_load_dwordx4 v245, s[12:15], s32 offen lds
    s_add_u32 m0, s24, 122880
    s_mov_b32 s32, 2490368
    buffer_load_dwordx4 v245, s[12:15], s32 offen lds
    v_mfma_f32_32x32x16_bf16 v[32:47], v[216:219], v[108:111], v[32:47]
    s_add_u32 m0, s24, 155648
    s_mov_b32 s32, 576
    buffer_load_dwordx4 v246, s[16:19], s32 offen lds
    v_mfma_f32_32x32x16_bf16 v[48:63], v[220:223], v[108:111], v[48:63]
    s_waitcnt vmcnt(14)
    s_waitcnt lgkmcnt(0)
    s_barrier
    v_mfma_f32_32x32x16_bf16 v[0:15], v[160:163], v[96:99], v[0:15]
    ds_read_b128 v[104:107], v152 offset:40960
    ds_read_b128 v[108:111], v153 offset:40960
    ds_read_b64_tr_b16 v[192:193], v148 offset:16384
    v_mfma_f32_32x32x16_bf16 v[16:31], v[164:167], v[96:99], v[16:31]
    ds_read_b64_tr_b16 v[194:195], v148 offset:18432
    ds_read_b64_tr_b16 v[196:197], v149 offset:16384
    ds_read_b64_tr_b16 v[198:199], v149 offset:18432
    ds_read_b64_tr_b16 v[200:201], v150 offset:16384
    v_mfma_f32_32x32x16_bf16 v[32:47], v[168:171], v[96:99], v[32:47]
    ds_read_b64_tr_b16 v[202:203], v150 offset:18432
    ds_read_b64_tr_b16 v[204:205], v151 offset:16384
    ds_read_b64_tr_b16 v[206:207], v151 offset:18432
    v_mfma_f32_32x32x16_bf16 v[48:63], v[172:175], v[96:99], v[48:63]
    ds_read_b64_tr_b16 v[208:209], v148 offset:20480
    ds_read_b64_tr_b16 v[210:211], v148 offset:22528
    ds_read_b64_tr_b16 v[212:213], v149 offset:20480
    v_mfma_f32_32x32x16_bf16 v[0:15], v[176:179], v[100:103], v[0:15]
    ds_read_b64_tr_b16 v[214:215], v149 offset:22528
    ds_read_b64_tr_b16 v[216:217], v150 offset:20480
    s_waitcnt lgkmcnt(13)
    ds_read_b64_tr_b16 v[218:219], v150 offset:22528
    v_mfma_f32_32x32x16_bf16 v[16:31], v[180:183], v[100:103], v[16:31]
    ds_read_b64_tr_b16 v[220:221], v151 offset:20480
    s_waitcnt lgkmcnt(13)
    ds_read_b64_tr_b16 v[222:223], v151 offset:22528
    s_add_u32 m0, s24, 0
    s_mov_b32 s32, 2621440
    buffer_load_dwordx4 v245, s[12:15], s32 offen lds
    s_add_u32 m0, s24, 8192
    s_mov_b32 s32, 2752512
    buffer_load_dwordx4 v245, s[12:15], s32 offen lds
    v_mfma_f32_32x32x16_bf16 v[32:47], v[184:187], v[100:103], v[32:47]
    s_add_u32 m0, s24, 32768
    s_mov_b32 s32, 640
    buffer_load_dwordx4 v246, s[16:19], s32 offen lds
    v_mfma_f32_32x32x16_bf16 v[48:63], v[188:191], v[100:103], v[48:63]
    s_waitcnt vmcnt(14)
    s_waitcnt lgkmcnt(0)
    s_barrier
    v_mfma_f32_32x32x16_bf16 v[0:15], v[192:195], v[104:107], v[0:15]
    ds_read_b128 v[96:99], v126 offset:0
    ds_read_b128 v[100:103], v127 offset:0
    ds_read_b64_tr_b16 v[160:161], v247 offset:0
    ds_read_b64_tr_b16 v[162:163], v247 offset:2048
    v_mfma_f32_32x32x16_bf16 v[16:31], v[196:199], v[104:107], v[16:31]
    ds_read_b64_tr_b16 v[164:165], v248 offset:0
    ds_read_b64_tr_b16 v[166:167], v248 offset:2048
    ds_read_b64_tr_b16 v[168:169], v249 offset:0
    v_mfma_f32_32x32x16_bf16 v[32:47], v[200:203], v[104:107], v[32:47]
    ds_read_b64_tr_b16 v[170:171], v249 offset:2048
    ds_read_b64_tr_b16 v[172:173], v250 offset:0
    ds_read_b64_tr_b16 v[174:175], v250 offset:2048
    ds_read_b64_tr_b16 v[176:177], v247 offset:4096
    v_mfma_f32_32x32x16_bf16 v[48:63], v[204:207], v[104:107], v[48:63]
    ds_read_b64_tr_b16 v[178:179], v247 offset:6144
    ds_read_b64_tr_b16 v[180:181], v248 offset:4096
    ds_read_b64_tr_b16 v[182:183], v248 offset:6144
    ds_read_b64_tr_b16 v[184:185], v249 offset:4096
    v_mfma_f32_32x32x16_bf16 v[0:15], v[208:211], v[108:111], v[0:15]
    s_waitcnt lgkmcnt(13)
    ds_read_b64_tr_b16 v[186:187], v249 offset:6144
    ds_read_b64_tr_b16 v[188:189], v250 offset:4096
    s_waitcnt lgkmcnt(13)
    ds_read_b64_tr_b16 v[190:191], v250 offset:6144
    v_mfma_f32_32x32x16_bf16 v[16:31], v[212:215], v[108:111], v[16:31]
    s_add_u32 m0, s24, 16384
    s_mov_b32 s32, 2883584
    buffer_load_dwordx4 v245, s[12:15], s32 offen lds
    s_add_u32 m0, s24, 24576
    s_mov_b32 s32, 3014656
    buffer_load_dwordx4 v245, s[12:15], s32 offen lds
    s_add_u32 m0, s24, 40960
    s_mov_b32 s32, 704
    buffer_load_dwordx4 v246, s[16:19], s32 offen lds
    buffer_store_dwordx4 v[128:131], v140, s[40:43], 0 offen
    v_mfma_f32_32x32x16_bf16 v[32:47], v[216:219], v[108:111], v[32:47]
    buffer_store_dwordx4 v[132:135], v141, s[40:43], 0 offen
    buffer_store_dwordx4 v[136:139], v142, s[40:43], 0 offen
    v_mfma_f32_32x32x16_bf16 v[48:63], v[220:223], v[108:111], v[48:63]
    s_waitcnt vmcnt(16)
    s_waitcnt lgkmcnt(0)
    s_barrier
    v_mfma_f32_32x32x16_bf16 v[0:15], v[160:163], v[96:99], v[0:15]
    ds_read_b128 v[104:107], v126 offset:8192
    ds_read_b128 v[108:111], v127 offset:8192
    ds_read_b64_tr_b16 v[192:193], v247 offset:16384
    v_mfma_f32_32x32x16_bf16 v[16:31], v[164:167], v[96:99], v[16:31]
    ds_read_b64_tr_b16 v[194:195], v247 offset:18432
    ds_read_b64_tr_b16 v[196:197], v248 offset:16384
    ds_read_b64_tr_b16 v[198:199], v248 offset:18432
    ds_read_b64_tr_b16 v[200:201], v249 offset:16384
    v_mfma_f32_32x32x16_bf16 v[32:47], v[168:171], v[96:99], v[32:47]
    ds_read_b64_tr_b16 v[202:203], v249 offset:18432
    ds_read_b64_tr_b16 v[204:205], v250 offset:16384
    ds_read_b64_tr_b16 v[206:207], v250 offset:18432
    v_mfma_f32_32x32x16_bf16 v[48:63], v[172:175], v[96:99], v[48:63]
    ds_read_b64_tr_b16 v[208:209], v247 offset:20480
    ds_read_b64_tr_b16 v[210:211], v247 offset:22528
    ds_read_b64_tr_b16 v[212:213], v248 offset:20480
    v_mfma_f32_32x32x16_bf16 v[0:15], v[176:179], v[100:103], v[0:15]
    ds_read_b64_tr_b16 v[214:215], v248 offset:22528
    ds_read_b64_tr_b16 v[216:217], v249 offset:20480
    s_waitcnt lgkmcnt(13)
    ds_read_b64_tr_b16 v[218:219], v249 offset:22528
    v_mfma_f32_32x32x16_bf16 v[16:31], v[180:183], v[100:103], v[16:31]
    ds_read_b64_tr_b16 v[220:221], v250 offset:20480
    s_waitcnt lgkmcnt(13)
    ds_read_b64_tr_b16 v[222:223], v250 offset:22528
    s_add_u32 m0, s24, 65536
    s_mov_b32 s32, 3145728
    buffer_load_dwordx4 v245, s[12:15], s32 offen lds
    s_add_u32 m0, s24, 73728
    s_mov_b32 s32, 3276800
    buffer_load_dwordx4 v245, s[12:15], s32 offen lds
    v_mfma_f32_32x32x16_bf16 v[32:47], v[184:187], v[100:103], v[32:47]
    s_add_u32 m0, s24, 131072
    s_mov_b32 s32, 768
    buffer_load_dwordx4 v246, s[16:19], s32 offen lds
    v_mfma_f32_32x32x16_bf16 v[48:63], v[188:191], v[100:103], v[48:63]
    s_waitcnt vmcnt(15)
    s_waitcnt lgkmcnt(0)
    s_barrier
    v_mfma_f32_32x32x16_bf16 v[0:15], v[192:195], v[104:107], v[0:15]
    ds_read_b128 v[96:99], v126 offset:16384
    ds_read_b128 v[100:103], v127 offset:16384
    ds_read_b64_tr_b16 v[160:161], v247 offset:32768
    v_mfma_f32_32x32x16_bf16 v[16:31], v[196:199], v[104:107], v[16:31]
    ds_read_b64_tr_b16 v[162:163], v247 offset:34816
    ds_read_b64_tr_b16 v[164:165], v248 offset:32768
    ds_read_b64_tr_b16 v[166:167], v248 offset:34816
    ds_read_b64_tr_b16 v[168:169], v249 offset:32768
    v_mfma_f32_32x32x16_bf16 v[32:47], v[200:203], v[104:107], v[32:47]
    ds_read_b64_tr_b16 v[170:171], v249 offset:34816
    ds_read_b64_tr_b16 v[172:173], v250 offset:32768
    ds_read_b64_tr_b16 v[174:175], v250 offset:34816
    v_mfma_f32_32x32x16_bf16 v[48:63], v[204:207], v[104:107], v[48:63]
    ds_read_b64_tr_b16 v[176:177], v247 offset:36864
    ds_read_b64_tr_b16 v[178:179], v247 offset:38912
    ds_read_b64_tr_b16 v[180:181], v248 offset:36864
    v_mfma_f32_32x32x16_bf16 v[0:15], v[208:211], v[108:111], v[0:15]
    ds_read_b64_tr_b16 v[182:183], v248 offset:38912
    ds_read_b64_tr_b16 v[184:185], v249 offset:36864
    s_waitcnt lgkmcnt(13)
    ds_read_b64_tr_b16 v[186:187], v249 offset:38912
    v_mfma_f32_32x32x16_bf16 v[16:31], v[212:215], v[108:111], v[16:31]
    ds_read_b64_tr_b16 v[188:189], v250 offset:36864
    s_waitcnt lgkmcnt(13)
    ds_read_b64_tr_b16 v[190:191], v250 offset:38912
    s_add_u32 m0, s24, 81920
    s_mov_b32 s32, 3407872
    buffer_load_dwordx4 v245, s[12:15], s32 offen lds
    s_add_u32 m0, s24, 90112
    s_mov_b32 s32, 3538944
    buffer_load_dwordx4 v245, s[12:15], s32 offen lds
    v_mfma_f32_32x32x16_bf16 v[32:47], v[216:219], v[108:111], v[32:47]
    s_add_u32 m0, s24, 139264
    s_mov_b32 s32, 832
    buffer_load_dwordx4 v246, s[16:19], s32 offen lds
    v_mfma_f32_32x32x16_bf16 v[48:63], v[220:223], v[108:111], v[48:63]
    s_waitcnt vmcnt(15)
    s_waitcnt lgkmcnt(0)
    s_barrier
    v_mfma_f32_32x32x16_bf16 v[0:15], v[160:163], v[96:99], v[0:15]
    ds_read_b128 v[104:107], v126 offset:24576
    ds_read_b128 v[108:111], v127 offset:24576
    ds_read_b64_tr_b16 v[192:193], v247 offset:49152
    v_mfma_f32_32x32x16_bf16 v[16:31], v[164:167], v[96:99], v[16:31]
    ds_read_b64_tr_b16 v[194:195], v247 offset:51200
    ds_read_b64_tr_b16 v[196:197], v248 offset:49152
    ds_read_b64_tr_b16 v[198:199], v248 offset:51200
    ds_read_b64_tr_b16 v[200:201], v249 offset:49152
    v_mfma_f32_32x32x16_bf16 v[32:47], v[168:171], v[96:99], v[32:47]
    ds_read_b64_tr_b16 v[202:203], v249 offset:51200
    ds_read_b64_tr_b16 v[204:205], v250 offset:49152
    ds_read_b64_tr_b16 v[206:207], v250 offset:51200
    v_mfma_f32_32x32x16_bf16 v[48:63], v[172:175], v[96:99], v[48:63]
    ds_read_b64_tr_b16 v[208:209], v247 offset:53248
    ds_read_b64_tr_b16 v[210:211], v247 offset:55296
    ds_read_b64_tr_b16 v[212:213], v248 offset:53248
    v_mfma_f32_32x32x16_bf16 v[0:15], v[176:179], v[100:103], v[0:15]
    ds_read_b64_tr_b16 v[214:215], v248 offset:55296
    ds_read_b64_tr_b16 v[216:217], v249 offset:53248
    s_waitcnt lgkmcnt(13)
    ds_read_b64_tr_b16 v[218:219], v249 offset:55296
    v_mfma_f32_32x32x16_bf16 v[16:31], v[180:183], v[100:103], v[16:31]
    ds_read_b64_tr_b16 v[220:221], v250 offset:53248
    s_waitcnt lgkmcnt(13)
    ds_read_b64_tr_b16 v[222:223], v250 offset:55296
    s_add_u32 m0, s24, 98304
    s_mov_b32 s32, 3670016
    buffer_load_dwordx4 v245, s[12:15], s32 offen lds
    s_add_u32 m0, s24, 106496
    s_mov_b32 s32, 3801088
    buffer_load_dwordx4 v245, s[12:15], s32 offen lds
    v_mfma_f32_32x32x16_bf16 v[32:47], v[184:187], v[100:103], v[32:47]
    s_add_u32 m0, s24, 147456
    s_mov_b32 s32, 896
    buffer_load_dwordx4 v246, s[16:19], s32 offen lds
    v_mfma_f32_32x32x16_bf16 v[48:63], v[188:191], v[100:103], v[48:63]
    s_waitcnt vmcnt(15)
    s_waitcnt lgkmcnt(0)
    s_barrier
    v_mfma_f32_32x32x16_bf16 v[0:15], v[192:195], v[104:107], v[0:15]
    ds_read_b128 v[96:99], v152 offset:32768
    ds_read_b128 v[100:103], v153 offset:32768
    ds_read_b64_tr_b16 v[160:161], v148 offset:0
    v_mfma_f32_32x32x16_bf16 v[16:31], v[196:199], v[104:107], v[16:31]
    ds_read_b64_tr_b16 v[162:163], v148 offset:2048
    ds_read_b64_tr_b16 v[164:165], v149 offset:0
    ds_read_b64_tr_b16 v[166:167], v149 offset:2048
    ds_read_b64_tr_b16 v[168:169], v150 offset:0
    v_mfma_f32_32x32x16_bf16 v[32:47], v[200:203], v[104:107], v[32:47]
    ds_read_b64_tr_b16 v[170:171], v150 offset:2048
    ds_read_b64_tr_b16 v[172:173], v151 offset:0
    ds_read_b64_tr_b16 v[174:175], v151 offset:2048
    v_mfma_f32_32x32x16_bf16 v[48:63], v[204:207], v[104:107], v[48:63]
    ds_read_b64_tr_b16 v[176:177], v148 offset:4096
    ds_read_b64_tr_b16 v[178:179], v148 offset:6144
    ds_read_b64_tr_b16 v[180:181], v149 offset:4096
    v_mfma_f32_32x32x16_bf16 v[0:15], v[208:211], v[108:111], v[0:15]
    ds_read_b64_tr_b16 v[182:183], v149 offset:6144
    ds_read_b64_tr_b16 v[184:185], v150 offset:4096
    s_waitcnt lgkmcnt(13)
    ds_read_b64_tr_b16 v[186:187], v150 offset:6144
    v_mfma_f32_32x32x16_bf16 v[16:31], v[212:215], v[108:111], v[16:31]
    ds_read_b64_tr_b16 v[188:189], v151 offset:4096
    s_waitcnt lgkmcnt(13)
    ds_read_b64_tr_b16 v[190:191], v151 offset:6144
    s_add_u32 m0, s24, 114688
    s_mov_b32 s32, 3932160
    buffer_load_dwordx4 v245, s[12:15], s32 offen lds
    s_add_u32 m0, s24, 122880
    s_mov_b32 s32, 4063232
    buffer_load_dwordx4 v245, s[12:15], s32 offen lds
    v_mfma_f32_32x32x16_bf16 v[32:47], v[216:219], v[108:111], v[32:47]
    s_add_u32 m0, s24, 155648
    s_mov_b32 s32, 960
    buffer_load_dwordx4 v246, s[16:19], s32 offen lds
    v_mfma_f32_32x32x16_bf16 v[48:63], v[220:223], v[108:111], v[48:63]
    s_waitcnt vmcnt(15)
    s_waitcnt lgkmcnt(0)
    s_barrier
    v_mfma_f32_32x32x16_bf16 v[0:15], v[160:163], v[96:99], v[0:15]
    ds_read_b128 v[104:107], v152 offset:40960
    ds_read_b128 v[108:111], v153 offset:40960
    ds_read_b64_tr_b16 v[192:193], v148 offset:16384
    v_mfma_f32_32x32x16_bf16 v[16:31], v[164:167], v[96:99], v[16:31]
    ds_read_b64_tr_b16 v[194:195], v148 offset:18432
    ds_read_b64_tr_b16 v[196:197], v149 offset:16384
    ds_read_b64_tr_b16 v[198:199], v149 offset:18432
    v_mfma_f32_32x32x16_bf16 v[32:47], v[168:171], v[96:99], v[32:47]
    ds_read_b64_tr_b16 v[200:201], v150 offset:16384
    ds_read_b64_tr_b16 v[202:203], v150 offset:18432
    ds_read_b64_tr_b16 v[204:205], v151 offset:16384
    v_mfma_f32_32x32x16_bf16 v[48:63], v[172:175], v[96:99], v[48:63]
    ds_read_b64_tr_b16 v[206:207], v151 offset:18432
    ds_read_b64_tr_b16 v[208:209], v148 offset:20480
    ds_read_b64_tr_b16 v[210:211], v148 offset:22528
    v_mfma_f32_32x32x16_bf16 v[0:15], v[176:179], v[100:103], v[0:15]
    ds_read_b64_tr_b16 v[212:213], v149 offset:20480
    ds_read_b64_tr_b16 v[214:215], v149 offset:22528
    v_mfma_f32_32x32x16_bf16 v[16:31], v[180:183], v[100:103], v[16:31]
    ds_read_b64_tr_b16 v[216:217], v150 offset:20480
    s_waitcnt lgkmcnt(13)
    ds_read_b64_tr_b16 v[218:219], v150 offset:22528
    ds_read_b64_tr_b16 v[220:221], v151 offset:20480
    v_mfma_f32_32x32x16_bf16 v[32:47], v[184:187], v[100:103], v[32:47]
    s_waitcnt lgkmcnt(13)
    ds_read_b64_tr_b16 v[222:223], v151 offset:22528
    v_mfma_f32_32x32x16_bf16 v[48:63], v[188:191], v[100:103], v[48:63]
    s_waitcnt vmcnt(9)
    s_waitcnt lgkmcnt(0)
    s_barrier
    v_mfma_f32_32x32x16_bf16 v[0:15], v[192:195], v[104:107], v[0:15]
    ds_read_b128 v[96:99], v126 offset:0
    ds_read_b128 v[100:103], v127 offset:0
    ds_read_b64_tr_b16 v[160:161], v247 offset:0
    v_mfma_f32_32x32x16_bf16 v[16:31], v[196:199], v[104:107], v[16:31]
    ds_read_b64_tr_b16 v[162:163], v247 offset:2048
    ds_read_b64_tr_b16 v[164:165], v248 offset:0
    ds_read_b64_tr_b16 v[166:167], v248 offset:2048
    v_mfma_f32_32x32x16_bf16 v[32:47], v[200:203], v[104:107], v[32:47]
    ds_read_b64_tr_b16 v[168:169], v249 offset:0
    ds_read_b64_tr_b16 v[170:171], v249 offset:2048
    ds_read_b64_tr_b16 v[172:173], v250 offset:0
    v_mfma_f32_32x32x16_bf16 v[48:63], v[204:207], v[104:107], v[48:63]
    ds_read_b64_tr_b16 v[174:175], v250 offset:2048
    ds_read_b64_tr_b16 v[176:177], v247 offset:4096
    ds_read_b64_tr_b16 v[178:179], v247 offset:6144
    ds_read_b64_tr_b16 v[180:181], v248 offset:4096
    v_mfma_f32_32x32x16_bf16 v[0:15], v[208:211], v[108:111], v[0:15]
    ds_read_b64_tr_b16 v[182:183], v248 offset:6144
    ds_read_b64_tr_b16 v[184:185], v249 offset:4096
    s_waitcnt lgkmcnt(13)
    ds_read_b64_tr_b16 v[186:187], v249 offset:6144
    v_mfma_f32_32x32x16_bf16 v[16:31], v[212:215], v[108:111], v[16:31]
    ds_read_b64_tr_b16 v[188:189], v250 offset:4096
    s_waitcnt lgkmcnt(13)
    ds_read_b64_tr_b16 v[190:191], v250 offset:6144
    s_add_u32 m0, s24, 0
    s_mov_b32 s33, 16384
    buffer_load_dwordx4 v236, s[4:7], s33 offen nt lds
    v_mfma_f32_32x32x16_bf16 v[32:47], v[216:219], v[108:111], v[32:47]
    s_add_u32 m0, s24, 8192
    s_mov_b32 s33, 24576
    buffer_load_dwordx4 v236, s[4:7], s33 offen nt lds
    v_mfma_f32_32x32x16_bf16 v[48:63], v[220:223], v[108:111], v[48:63]
    s_waitcnt vmcnt(8)
    s_waitcnt lgkmcnt(0)
    s_barrier
    v_mfma_f32_32x32x16_bf16 v[0:15], v[160:163], v[96:99], v[0:15]
    ds_read_b128 v[104:107], v126 offset:8192
    ds_read_b128 v[108:111], v127 offset:8192
    ds_read_b64_tr_b16 v[192:193], v247 offset:16384
    v_mfma_f32_32x32x16_bf16 v[16:31], v[164:167], v[96:99], v[16:31]
    ds_read_b64_tr_b16 v[194:195], v247 offset:18432
    ds_read_b64_tr_b16 v[196:197], v248 offset:16384
    ds_read_b64_tr_b16 v[198:199], v248 offset:18432
    ds_read_b64_tr_b16 v[200:201], v249 offset:16384
    v_mfma_f32_32x32x16_bf16 v[32:47], v[168:171], v[96:99], v[32:47]
    ds_read_b64_tr_b16 v[202:203], v249 offset:18432
    ds_read_b64_tr_b16 v[204:205], v250 offset:16384
    ds_read_b64_tr_b16 v[206:207], v250 offset:18432
    v_mfma_f32_32x32x16_bf16 v[48:63], v[172:175], v[96:99], v[48:63]
    ds_read_b64_tr_b16 v[208:209], v247 offset:20480
    ds_read_b64_tr_b16 v[210:211], v247 offset:22528
    ds_read_b64_tr_b16 v[212:213], v248 offset:20480
    v_mfma_f32_32x32x16_bf16 v[0:15], v[176:179], v[100:103], v[0:15]
    ds_read_b64_tr_b16 v[214:215], v248 offset:22528
    ds_read_b64_tr_b16 v[216:217], v249 offset:20480
    s_waitcnt lgkmcnt(13)
    ds_read_b64_tr_b16 v[218:219], v249 offset:22528
    v_mfma_f32_32x32x16_bf16 v[16:31], v[180:183], v[100:103], v[16:31]
    ds_read_b64_tr_b16 v[220:221], v250 offset:20480
    s_waitcnt lgkmcnt(13)
    ds_read_b64_tr_b16 v[222:223], v250 offset:22528
    s_add_u32 m0, s24, 65536
    s_mov_b32 s32, 4194304
    buffer_load_dwordx4 v245, s[12:15], s32 offen lds
    s_add_u32 m0, s24, 73728
    s_mov_b32 s32, 4325376
    buffer_load_dwordx4 v245, s[12:15], s32 offen lds
    v_mfma_f32_32x32x16_bf16 v[32:47], v[184:187], v[100:103], v[32:47]
    s_add_u32 m0, s24, 131072
    s_mov_b32 s32, 1024
    buffer_load_dwordx4 v246, s[16:19], s32 offen lds
    v_mfma_f32_32x32x16_bf16 v[48:63], v[188:191], v[100:103], v[48:63]
    s_waitcnt vmcnt(8)
    s_waitcnt lgkmcnt(0)
    s_barrier
    v_mfma_f32_32x32x16_bf16 v[0:15], v[192:195], v[104:107], v[0:15]
    ds_read_b128 v[96:99], v126 offset:16384
    ds_read_b128 v[100:103], v127 offset:16384
    ds_read_b64_tr_b16 v[160:161], v247 offset:32768
    v_mfma_f32_32x32x16_bf16 v[16:31], v[196:199], v[104:107], v[16:31]
    ds_read_b64_tr_b16 v[162:163], v247 offset:34816
    ds_read_b64_tr_b16 v[164:165], v248 offset:32768
    ds_read_b64_tr_b16 v[166:167], v248 offset:34816
    ds_read_b64_tr_b16 v[168:169], v249 offset:32768
    v_mfma_f32_32x32x16_bf16 v[32:47], v[200:203], v[104:107], v[32:47]
    ds_read_b64_tr_b16 v[170:171], v249 offset:34816
    ds_read_b64_tr_b16 v[172:173], v250 offset:32768
    ds_read_b64_tr_b16 v[174:175], v250 offset:34816
    v_mfma_f32_32x32x16_bf16 v[48:63], v[204:207], v[104:107], v[48:63]
    ds_read_b64_tr_b16 v[176:177], v247 offset:36864
    ds_read_b64_tr_b16 v[178:179], v247 offset:38912
    ds_read_b64_tr_b16 v[180:181], v248 offset:36864
    v_mfma_f32_32x32x16_bf16 v[0:15], v[208:211], v[108:111], v[0:15]
    ds_read_b64_tr_b16 v[182:183], v248 offset:38912
    ds_read_b64_tr_b16 v[184:185], v249 offset:36864
    s_waitcnt lgkmcnt(13)
    ds_read_b64_tr_b16 v[186:187], v249 offset:38912
    v_mfma_f32_32x32x16_bf16 v[16:31], v[212:215], v[108:111], v[16:31]
    ds_read_b64_tr_b16 v[188:189], v250 offset:36864
    s_waitcnt lgkmcnt(13)
    ds_read_b64_tr_b16 v[190:191], v250 offset:38912
    s_add_u32 m0, s24, 81920
    s_mov_b32 s32, 4456448
    buffer_load_dwordx4 v245, s[12:15], s32 offen lds
    s_add_u32 m0, s24, 90112
    s_mov_b32 s32, 4587520
    buffer_load_dwordx4 v245, s[12:15], s32 offen lds
    v_mfma_f32_32x32x16_bf16 v[32:47], v[216:219], v[108:111], v[32:47]
    s_add_u32 m0, s24, 139264
    s_mov_b32 s32, 1088
    buffer_load_dwordx4 v246, s[16:19], s32 offen lds
    v_mfma_f32_32x32x16_bf16 v[48:63], v[220:223], v[108:111], v[48:63]
    s_waitcnt vmcnt(8)
    s_waitcnt lgkmcnt(0)
    s_barrier
    v_mfma_f32_32x32x16_bf16 v[0:15], v[160:163], v[96:99], v[0:15]
    ds_read_b128 v[104:107], v126 offset:24576
    ds_read_b128 v[108:111], v127 offset:24576
    ds_read_b64_tr_b16 v[192:193], v247 offset:49152
    v_mfma_f32_32x32x16_bf16 v[16:31], v[164:167], v[96:99], v[16:31]
    ds_read_b64_tr_b16 v[194:195], v247 offset:51200
    ds_read_b64_tr_b16 v[196:197], v248 offset:49152
    ds_read_b64_tr_b16 v[198:199], v248 offset:51200
    v_mfma_f32_32x32x16_bf16 v[32:47], v[168:171], v[96:99], v[32:47]
    ds_read_b64_tr_b16 v[200:201], v249 offset:49152
    ds_read_b64_tr_b16 v[202:203], v249 offset:51200
    ds_read_b64_tr_b16 v[204:205], v250 offset:49152
    v_mfma_f32_32x32x16_bf16 v[48:63], v[172:175], v[96:99], v[48:63]
    ds_read_b64_tr_b16 v[206:207], v250 offset:51200
    ds_read_b64_tr_b16 v[208:209], v247 offset:53248
    ds_read_b64_tr_b16 v[210:211], v247 offset:55296
    v_mfma_f32_32x32x16_bf16 v[0:15], v[176:179], v[100:103], v[0:15]
    ds_read_b64_tr_b16 v[212:213], v248 offset:53248
    ds_read_b64_tr_b16 v[214:215], v248 offset:55296
    ds_read_b64_tr_b16 v[216:217], v249 offset:53248
    v_mfma_f32_32x32x16_bf16 v[16:31], v[180:183], v[100:103], v[16:31]
    s_waitcnt lgkmcnt(13)
    ds_read_b64_tr_b16 v[218:219], v249 offset:55296
    ds_read_b64_tr_b16 v[220:221], v250 offset:53248
    s_waitcnt lgkmcnt(13)
    ds_read_b64_tr_b16 v[222:223], v250 offset:55296
    v_mfma_f32_32x32x16_bf16 v[32:47], v[184:187], v[100:103], v[32:47]
    s_add_u32 m0, s24, 16384
    s_mov_b32 s33, 32768
    buffer_load_dwordx4 v236, s[4:7], s33 offen nt lds
    v_mfma_f32_32x32x16_bf16 v[48:63], v[188:191], v[100:103], v[48:63]
    s_waitcnt vmcnt(4)
    s_waitcnt lgkmcnt(0)
    s_barrier
    v_mfma_f32_32x32x16_bf16 v[0:15], v[192:195], v[104:107], v[0:15]
    ds_read_b128 v[96:99], v126 offset:0
    ds_read_b128 v[100:103], v127 offset:0
    ds_read_b64_tr_b16 v[160:161], v247 offset:0
    v_mfma_f32_32x32x16_bf16 v[16:31], v[196:199], v[104:107], v[16:31]
    ds_read_b64_tr_b16 v[162:163], v247 offset:2048
    ds_read_b64_tr_b16 v[164:165], v248 offset:0
    ds_read_b64_tr_b16 v[166:167], v248 offset:2048
    v_mfma_f32_32x32x16_bf16 v[32:47], v[200:203], v[104:107], v[32:47]
    ds_read_b64_tr_b16 v[168:169], v249 offset:0
    ds_read_b64_tr_b16 v[170:171], v249 offset:2048
    ds_read_b64_tr_b16 v[172:173], v250 offset:0
    v_mfma_f32_32x32x16_bf16 v[48:63], v[204:207], v[104:107], v[48:63]
    ds_read_b64_tr_b16 v[174:175], v250 offset:2048
    ds_read_b64_tr_b16 v[176:177], v247 offset:4096
    ds_read_b64_tr_b16 v[178:179], v247 offset:6144
    v_mfma_f32_32x32x16_bf16 v[0:15], v[208:211], v[108:111], v[0:15]
    ds_read_b64_tr_b16 v[180:181], v248 offset:4096
    ds_read_b64_tr_b16 v[182:183], v248 offset:6144
    ds_read_b64_tr_b16 v[184:185], v249 offset:4096
    v_mfma_f32_32x32x16_bf16 v[16:31], v[212:215], v[108:111], v[16:31]
    s_waitcnt lgkmcnt(13)
    ds_read_b64_tr_b16 v[186:187], v249 offset:6144
    ds_read_b64_tr_b16 v[188:189], v250 offset:4096
    s_waitcnt lgkmcnt(13)
    ds_read_b64_tr_b16 v[190:191], v250 offset:6144
    v_mfma_f32_32x32x16_bf16 v[32:47], v[216:219], v[108:111], v[32:47]
    s_add_u32 m0, s24, 24576
    s_mov_b32 s33, 40960
    buffer_load_dwordx4 v236, s[4:7], s33 offen nt lds
    v_mfma_f32_32x32x16_bf16 v[48:63], v[220:223], v[108:111], v[48:63]
    s_waitcnt vmcnt(2)
    s_waitcnt lgkmcnt(0)
    s_barrier
    v_mfma_f32_32x32x16_bf16 v[0:15], v[160:163], v[96:99], v[0:15]
    ds_read_b128 v[104:107], v126 offset:8192
    ds_read_b128 v[108:111], v127 offset:8192
    ds_read_b64_tr_b16 v[192:193], v247 offset:16384
    v_mfma_f32_32x32x16_bf16 v[16:31], v[164:167], v[96:99], v[16:31]
    ds_read_b64_tr_b16 v[194:195], v247 offset:18432
    ds_read_b64_tr_b16 v[196:197], v248 offset:16384
    ds_read_b64_tr_b16 v[198:199], v248 offset:18432
    v_mfma_f32_32x32x16_bf16 v[32:47], v[168:171], v[96:99], v[32:47]
    ds_read_b64_tr_b16 v[200:201], v249 offset:16384
    ds_read_b64_tr_b16 v[202:203], v249 offset:18432
    ds_read_b64_tr_b16 v[204:205], v250 offset:16384
    v_mfma_f32_32x32x16_bf16 v[48:63], v[172:175], v[96:99], v[48:63]
    ds_read_b64_tr_b16 v[206:207], v250 offset:18432
    ds_read_b64_tr_b16 v[208:209], v247 offset:20480
    ds_read_b64_tr_b16 v[210:211], v247 offset:22528
    ds_read_b64_tr_b16 v[212:213], v248 offset:20480
    v_mfma_f32_32x32x16_bf16 v[0:15], v[176:179], v[100:103], v[0:15]
    ds_read_b64_tr_b16 v[214:215], v248 offset:22528
    ds_read_b64_tr_b16 v[216:217], v249 offset:20480
    s_waitcnt lgkmcnt(13)
    ds_read_b64_tr_b16 v[218:219], v249 offset:22528
    v_mfma_f32_32x32x16_bf16 v[16:31], v[180:183], v[100:103], v[16:31]
    ds_read_b64_tr_b16 v[220:221], v250 offset:20480
    s_waitcnt lgkmcnt(13)
    ds_read_b64_tr_b16 v[222:223], v250 offset:22528
    s_add_u32 m0, s24, 65536
    s_mov_b32 s33, 0
    buffer_load_dwordx4 v237, s[8:11], s33 offen nt lds
    v_mfma_f32_32x32x16_bf16 v[32:47], v[184:187], v[100:103], v[32:47]
    s_add_u32 m0, s24, 73728
    s_mov_b32 s33, 8192
    buffer_load_dwordx4 v237, s[8:11], s33 offen nt lds
    v_mfma_f32_32x32x16_bf16 v[48:63], v[188:191], v[100:103], v[48:63]
    s_waitcnt lgkmcnt(0)
    s_barrier
    v_mfma_f32_32x32x16_bf16 v[0:15], v[192:195], v[104:107], v[0:15]
    s_add_u32 m0, s24, 81920
    s_mov_b32 s33, 16384
    buffer_load_dwordx4 v237, s[8:11], s33 offen nt lds
    v_mfma_f32_32x32x16_bf16 v[16:31], v[196:199], v[104:107], v[16:31]
    s_add_u32 m0, s24, 90112
    s_mov_b32 s33, 24576
    buffer_load_dwordx4 v237, s[8:11], s33 offen nt lds
    v_mfma_f32_32x32x16_bf16 v[32:47], v[200:203], v[104:107], v[32:47]
    s_add_u32 m0, s24, 32768
    s_mov_b32 s33, 49152
    buffer_load_dwordx4 v236, s[4:7], s33 offen nt lds
    v_mfma_f32_32x32x16_bf16 v[48:63], v[204:207], v[104:107], v[48:63]
    s_add_u32 m0, s24, 40960
    s_mov_b32 s33, 57344
    buffer_load_dwordx4 v236, s[4:7], s33 offen nt lds
    v_mfma_f32_32x32x16_bf16 v[0:15], v[208:211], v[108:111], v[0:15]
    v_mfma_f32_32x32x16_bf16 v[16:31], v[212:215], v[108:111], v[16:31]
    v_mfma_f32_32x32x16_bf16 v[32:47], v[216:219], v[108:111], v[32:47]
    v_mfma_f32_32x32x16_bf16 v[48:63], v[220:223], v[108:111], v[48:63]
    s_mov_b32 s32, s25
    s_mov_b32 s33, s25
    s_nop 6
    v_pk_mul_f32 v[0:1], v[0:1], s[32:33]
    v_pk_mul_f32 v[2:3], v[2:3], s[32:33]
    v_pk_mul_f32 v[4:5], v[4:5], s[32:33]
    v_pk_mul_f32 v[6:7], v[6:7], s[32:33]
    v_pk_mul_f32 v[8:9], v[8:9], s[32:33]
    v_pk_mul_f32 v[10:11], v[10:11], s[32:33]
    v_pk_mul_f32 v[12:13], v[12:13], s[32:33]
    v_pk_mul_f32 v[14:15], v[14:15], s[32:33]
    v_pk_mul_f32 v[16:17], v[16:17], s[32:33]
    v_pk_mul_f32 v[18:19], v[18:19], s[32:33]
    v_pk_mul_f32 v[20:21], v[20:21], s[32:33]
    v_pk_mul_f32 v[22:23], v[22:23], s[32:33]
    v_pk_mul_f32 v[24:25], v[24:25], s[32:33]
    v_pk_mul_f32 v[26:27], v[26:27], s[32:33]
    v_pk_mul_f32 v[28:29], v[28:29], s[32:33]
    v_pk_mul_f32 v[30:31], v[30:31], s[32:33]
    v_pk_mul_f32 v[32:33], v[32:33], s[32:33]
    v_pk_mul_f32 v[34:35], v[34:35], s[32:33]
    v_pk_mul_f32 v[36:37], v[36:37], s[32:33]
    v_pk_mul_f32 v[38:39], v[38:39], s[32:33]
    v_pk_mul_f32 v[40:41], v[40:41], s[32:33]
    v_pk_mul_f32 v[42:43], v[42:43], s[32:33]
    v_pk_mul_f32 v[44:45], v[44:45], s[32:33]
    v_pk_mul_f32 v[46:47], v[46:47], s[32:33]
    v_pk_mul_f32 v[48:49], v[48:49], s[32:33]
    v_pk_mul_f32 v[50:51], v[50:51], s[32:33]
    v_pk_mul_f32 v[52:53], v[52:53], s[32:33]
    v_pk_mul_f32 v[54:55], v[54:55], s[32:33]
    v_pk_mul_f32 v[56:57], v[56:57], s[32:33]
    v_pk_mul_f32 v[58:59], v[58:59], s[32:33]
    v_pk_mul_f32 v[60:61], v[60:61], s[32:33]
    v_pk_mul_f32 v[62:63], v[62:63], s[32:33]
    v_cvt_pk_bf16_f32 v64, v0, v1
    v_cvt_pk_bf16_f32 v65, v2, v3
    v_cvt_pk_bf16_f32 v66, v4, v5
    v_cvt_pk_bf16_f32 v67, v6, v7
    v_cvt_pk_bf16_f32 v68, v8, v9
    v_cvt_pk_bf16_f32 v69, v10, v11
    v_cvt_pk_bf16_f32 v70, v12, v13
    v_cvt_pk_bf16_f32 v71, v14, v15
    v_cvt_pk_bf16_f32 v72, v16, v17
    v_cvt_pk_bf16_f32 v73, v18, v19
    v_cvt_pk_bf16_f32 v74, v20, v21
    v_cvt_pk_bf16_f32 v75, v22, v23
    v_cvt_pk_bf16_f32 v76, v24, v25
    v_cvt_pk_bf16_f32 v77, v26, v27
    v_cvt_pk_bf16_f32 v78, v28, v29
    v_cvt_pk_bf16_f32 v79, v30, v31
    v_cvt_pk_bf16_f32 v80, v32, v33
    v_cvt_pk_bf16_f32 v81, v34, v35
    v_cvt_pk_bf16_f32 v82, v36, v37
    v_cvt_pk_bf16_f32 v83, v38, v39
    v_cvt_pk_bf16_f32 v84, v40, v41
    v_cvt_pk_bf16_f32 v85, v42, v43
    v_cvt_pk_bf16_f32 v86, v44, v45
    v_cvt_pk_bf16_f32 v87, v46, v47
    v_cvt_pk_bf16_f32 v88, v48, v49
    v_cvt_pk_bf16_f32 v89, v50, v51
    v_cvt_pk_bf16_f32 v90, v52, v53
    v_cvt_pk_bf16_f32 v91, v54, v55
    v_cvt_pk_bf16_f32 v92, v56, v57
    v_cvt_pk_bf16_f32 v93, v58, v59
    v_cvt_pk_bf16_f32 v94, v60, v61
    v_cvt_pk_bf16_f32 v95, v62, v63
    v_permlane32_swap_b32 v64, v66
    v_permlane32_swap_b32 v65, v67
    v_permlane32_swap_b32 v68, v70
    v_permlane32_swap_b32 v69, v71
    v_permlane32_swap_b32 v72, v74
    v_permlane32_swap_b32 v73, v75
    v_permlane32_swap_b32 v76, v78
    v_permlane32_swap_b32 v77, v79
    v_permlane32_swap_b32 v80, v82
    v_permlane32_swap_b32 v81, v83
    v_permlane32_swap_b32 v84, v86
    v_permlane32_swap_b32 v85, v87
    v_permlane32_swap_b32 v88, v90
    v_permlane32_swap_b32 v89, v91
    v_permlane32_swap_b32 v92, v94
    v_permlane32_swap_b32 v93, v95
    s_mov_b32 s28, 65536
    s_mov_b32 s29, 73728
    s_mov_b32 s30, 32768
    s_mov_b32 s31, 40960
    s_barrier
    ds_read_b128 v[160:163], v224 offset:49152
    ds_read_b128 v[164:167], v225 offset:49152
    ds_read_b128 v[168:171], v226 offset:49152
    ds_read_b128 v[172:175], v227 offset:49152
    s_waitcnt lgkmcnt(3)
    v_mfma_f32_32x32x16_bf16 v[96:111], v[160:163], v[64:67], 0
    ds_read_b128 v[160:163], v228 offset:49152
    v_mov_b32 v238, 0
    s_waitcnt lgkmcnt(3)
    v_mfma_f32_32x32x16_bf16 v[96:111], v[164:167], v[68:71], v[96:111]
    ds_read_b128 v[164:167], v229 offset:49152
    v_mov_b32 v239, 0
    s_waitcnt lgkmcnt(3)
    v_mfma_f32_32x32x16_bf16 v[96:111], v[168:171], v[72:75], v[96:111]
    ds_read_b128 v[168:171], v230 offset:49152
    s_waitcnt lgkmcnt(3)
    v_mfma_f32_32x32x16_bf16 v[96:111], v[172:175], v[76:79], v[96:111]
    ds_read_b128 v[172:175], v231 offset:49152
    v_mov_b32 v240, 0
    s_waitcnt lgkmcnt(3)
    v_mfma_f32_32x32x16_bf16 v[96:111], v[160:163], v[80:83], v[96:111]
    ds_read_b128 v[160:163], v224 offset:57344
    v_mov_b32 v241, 0
    s_waitcnt lgkmcnt(3)
    v_mfma_f32_32x32x16_bf16 v[96:111], v[164:167], v[84:87], v[96:111]
    ds_read_b128 v[164:167], v225 offset:57344
    s_waitcnt lgkmcnt(3)
    v_mfma_f32_32x32x16_bf16 v[96:111], v[168:171], v[88:91], v[96:111]
    ds_read_b128 v[168:171], v226 offset:57344
    s_waitcnt lgkmcnt(3)
    v_mfma_f32_32x32x16_bf16 v[96:111], v[172:175], v[92:95], v[96:111]
    ds_read_b128 v[172:175], v227 offset:57344
    s_waitcnt lgkmcnt(3)
    v_mfma_f32_32x32x16_bf16 v[112:127], v[160:163], v[64:67], 0
    ds_read_b128 v[160:163], v228 offset:57344
    s_waitcnt lgkmcnt(3)
    v_mfma_f32_32x32x16_bf16 v[112:127], v[164:167], v[68:71], v[112:127]
    ds_read_b128 v[164:167], v229 offset:57344
    s_waitcnt lgkmcnt(3)
    v_mfma_f32_32x32x16_bf16 v[112:127], v[168:171], v[72:75], v[112:127]
    ds_read_b128 v[168:171], v230 offset:57344
    v_and_b32 v243, 31, v252
    v_cmp_eq_u32 vcc, 0, v243
    v_cmp_eq_u32 s[32:33], 17, v243
    s_nop 4
    s_or_b64 vcc, vcc, s[32:33]
    v_mov_b32 v244, 0x3f803f80
    s_nop 2
    v_cndmask_b32 v246, 0, v244, vcc
    v_cndmask_b32 v247, 0, v244, vcc
    v_cndmask_b32 v248, 0, v244, vcc
    v_cndmask_b32 v249, 0, v244, vcc
    s_waitcnt lgkmcnt(3)
    v_mfma_f32_32x32x16_bf16 v[112:127], v[172:175], v[76:79], v[112:127]
    ds_read_b128 v[172:175], v231 offset:57344
    s_waitcnt lgkmcnt(3)
    v_mfma_f32_32x32x16_bf16 v[112:127], v[160:163], v[80:83], v[112:127]
    s_waitcnt lgkmcnt(2)
    v_mfma_f32_32x32x16_bf16 v[112:127], v[164:167], v[84:87], v[112:127]
    s_waitcnt lgkmcnt(1)
    v_mfma_f32_32x32x16_bf16 v[112:127], v[168:171], v[88:91], v[112:127]
    s_waitcnt lgkmcnt(0)
    v_mfma_f32_32x32x16_bf16 v[112:127], v[172:175], v[92:95], v[112:127]
    s_waitcnt vmcnt(4)
    s_barrier
    s_add_u32 m0, s24, 98304
    s_nop 0
    buffer_load_dwordx4 v237, s[8:11], s30 offen nt lds
    s_add_u32 m0, s24, 106496
    s_nop 0
    buffer_load_dwordx4 v237, s[8:11], s31 offen nt lds
    s_add_u32 m0, s24, 49152
    s_nop 0
    buffer_load_dwordx4 v236, s[4:7], s28 offen nt lds
    s_add_u32 m0, s24, 57344
    s_nop 0
    buffer_load_dwordx4 v236, s[4:7], s29 offen nt lds
    s_add_u32 s28, s28, 16384
    s_add_u32 s29, s29, 16384
    s_add_u32 s30, s30, 16384
    s_add_u32 s31, s31, 16384
    ds_read_b128 v[160:163], v224 offset:0
    ds_read_b128 v[164:167], v225 offset:0
    ds_read_b128 v[168:171], v226 offset:0
    ds_read_b128 v[172:175], v227 offset:0
    v_max3_f32 v242, v96, v97, v98
    v_max3_f32 v244, v99, v100, v101
    v_max3_f32 v242, v242, v102, v103
    v_max3_f32 v244, v244, v104, v105
    v_max3_f32 v242, v242, v106, v107
    v_max3_f32 v244, v244, v108, v109
    v_max3_f32 v242, v242, v110, v111
    v_max3_f32 v244, v244, v112, v113
    v_max3_f32 v242, v242, v114, v115
    v_max3_f32 v244, v244, v116, v117
    v_max3_f32 v242, v242, v118, v119
    v_max3_f32 v244, v244, v120, v121
    v_max3_f32 v242, v242, v122, v123
    v_max3_f32 v244, v244, v124, v125
    v_max3_f32 v242, v242, v126, v127
    v_max_f32 v242, v242, v244
    v_mov_b32 v243, v242
    s_nop 1
    v_permlane32_swap_b32 v242, v243
    v_max_f32 v242, v242, v243
    v_cmp_lt_f32 vcc, s26, v242
    v_sub_f32 v96, v96, v242
    v_sub_f32 v97, v97, v242
    v_sub_f32 v98, v98, v242
    v_sub_f32 v99, v99, v242
    v_sub_f32 v100, v100, v242
    v_sub_f32 v101, v101, v242
    v_sub_f32 v102, v102, v242
    v_sub_f32 v103, v103, v242
    v_sub_f32 v104, v104, v242
    v_sub_f32 v105, v105, v242
    v_sub_f32 v106, v106, v242
    v_sub_f32 v107, v107, v242
    v_sub_f32 v108, v108, v242
    v_sub_f32 v109, v109, v242
    v_sub_f32 v110, v110, v242
    v_sub_f32 v111, v111, v242
    v_sub_f32 v112, v112, v242
    v_sub_f32 v113, v113, v242
    v_sub_f32 v114, v114, v242
    v_sub_f32 v115, v115, v242
    v_sub_f32 v116, v116, v242
    v_sub_f32 v117, v117, v242
    v_sub_f32 v118, v118, v242
    v_sub_f32 v119, v119, v242
    v_sub_f32 v120, v120, v242
    v_sub_f32 v121, v121, v242
    v_sub_f32 v122, v122, v242
    v_sub_f32 v123, v123, v242
    v_sub_f32 v124, v124, v242
    v_sub_f32 v125, v125, v242
    v_sub_f32 v126, v126, v242
    v_sub_f32 v127, v127, v242
    v_sub_f32 v176, 0, v242
    v_sub_f32 v177, 0, v242
    v_sub_f32 v178, 0, v242
    v_sub_f32 v179, 0, v242
    v_sub_f32 v180, 0, v242
    v_sub_f32 v181, 0, v242
    v_sub_f32 v182, 0, v242
    v_sub_f32 v183, 0, v242
    v_sub_f32 v184, 0, v242
    v_sub_f32 v185, 0, v242
    v_sub_f32 v186, 0, v242
    v_sub_f32 v187, 0, v242
    v_sub_f32 v188, 0, v242
    v_sub_f32 v189, 0, v242
    v_sub_f32 v190, 0, v242
    v_sub_f32 v191, 0, v242
    s_waitcnt lgkmcnt(3)
    s_nop 0
    v_mfma_f32_32x32x16_bf16 v[128:143], v[160:163], v[64:67], v[176:191]
    ds_read_b128 v[160:163], v228 offset:0
    v_exp_f32 v96, v96
    v_exp_f32 v97, v97
    s_waitcnt lgkmcnt(3)
    v_mfma_f32_32x32x16_bf16 v[128:143], v[164:167], v[68:71], v[128:143]
    ds_read_b128 v[164:167], v229 offset:0
    v_exp_f32 v98, v98
    v_exp_f32 v99, v99
    v_cvt_pk_bf16_f32 v96, v96, v97
    s_waitcnt lgkmcnt(3)
    v_mfma_f32_32x32x16_bf16 v[128:143], v[168:171], v[72:75], v[128:143]
    ds_read_b128 v[168:171], v230 offset:0
    v_cvt_pk_bf16_f32 v97, v98, v99
    v_exp_f32 v100, v100
    s_waitcnt lgkmcnt(3)
    v_mfma_f32_32x32x16_bf16 v[128:143], v[172:175], v[76:79], v[128:143]
    ds_read_b128 v[172:175], v231 offset:0
    v_exp_f32 v101, v101
    v_exp_f32 v102, v102
    v_exp_f32 v103, v103
    s_waitcnt lgkmcnt(3)
    v_mfma_f32_32x32x16_bf16 v[128:143], v[160:163], v[80:83], v[128:143]
    ds_read_b128 v[160:163], v224 offset:8192
    v_cvt_pk_bf16_f32 v98, v100, v101
    v_cvt_pk_bf16_f32 v99, v102, v103
    v_exp_f32 v104, v104
    s_waitcnt lgkmcnt(3)
    v_mfma_f32_32x32x16_bf16 v[128:143], v[164:167], v[84:87], v[128:143]
    ds_read_b128 v[164:167], v225 offset:8192
    v_exp_f32 v105, v105
    v_exp_f32 v106, v106
    s_waitcnt lgkmcnt(3)
    v_mfma_f32_32x32x16_bf16 v[128:143], v[168:171], v[88:91], v[128:143]
    ds_read_b128 v[168:171], v226 offset:8192
    v_exp_f32 v107, v107
    v_cvt_pk_bf16_f32 v100, v104, v105
    v_cvt_pk_bf16_f32 v101, v106, v107
    s_waitcnt lgkmcnt(3)
    v_mfma_f32_32x32x16_bf16 v[128:143], v[172:175], v[92:95], v[128:143]
    ds_read_b128 v[172:175], v227 offset:8192
    v_exp_f32 v108, v108
    v_exp_f32 v109, v109
    s_waitcnt lgkmcnt(3)
    v_mfma_f32_32x32x16_bf16 v[144:159], v[160:163], v[64:67], v[176:191]
    ds_read_b128 v[160:163], v228 offset:8192
    v_exp_f32 v110, v110
    v_exp_f32 v111, v111
    s_waitcnt lgkmcnt(3)
    v_mfma_f32_32x32x16_bf16 v[144:159], v[164:167], v[68:71], v[144:159]
    ds_read_b128 v[164:167], v229 offset:8192
    v_cvt_pk_bf16_f32 v102, v108, v109
    v_cvt_pk_bf16_f32 v103, v110, v111
    v_exp_f32 v112, v112
    ds_read_b64_tr_b16 v[192:193], v232 offset:0
    s_waitcnt lgkmcnt(4)
    v_mfma_f32_32x32x16_bf16 v[144:159], v[168:171], v[72:75], v[144:159]
    ds_read_b128 v[168:171], v230 offset:8192
    v_exp_f32 v113, v113
    ds_read_b64_tr_b16 v[194:195], v232 offset:2048
    v_exp_f32 v114, v114
    s_waitcnt lgkmcnt(5)
    v_mfma_f32_32x32x16_bf16 v[144:159], v[172:175], v[76:79], v[144:159]
    ds_read_b128 v[172:175], v231 offset:8192
    ds_read_b64_tr_b16 v[196:197], v233 offset:0
    v_exp_f32 v115, v115
    ds_read_b64_tr_b16 v[198:199], v233 offset:2048
    v_cvt_pk_bf16_f32 v104, v112, v113
    s_waitcnt lgkmcnt(7)
    v_mfma_f32_32x32x16_bf16 v[144:159], v[160:163], v[80:83], v[144:159]
    ds_read_b64_tr_b16 v[200:201], v234 offset:0
    v_cvt_pk_bf16_f32 v105, v114, v115
    ds_read_b64_tr_b16 v[202:203], v234 offset:2048
    v_exp_f32 v116, v116
    ds_read_b64_tr_b16 v[204:205], v235 offset:0
    s_waitcnt lgkmcnt(9)
    v_mfma_f32_32x32x16_bf16 v[144:159], v[164:167], v[84:87], v[144:159]
    v_exp_f32 v117, v117
    ds_read_b64_tr_b16 v[206:207], v235 offset:2048
    v_exp_f32 v118, v118
    s_waitcnt lgkmcnt(8)
    v_mfma_f32_32x32x16_bf16 v[144:159], v[168:171], v[88:91], v[144:159]
    ds_read_b64_tr_b16 v[208:209], v232 offset:4096
    v_exp_f32 v119, v119
    ds_read_b64_tr_b16 v[210:211], v232 offset:6144
    v_cvt_pk_bf16_f32 v106, v116, v117
    s_waitcnt lgkmcnt(8)
    v_mfma_f32_32x32x16_bf16 v[144:159], v[172:175], v[92:95], v[144:159]
    ds_read_b64_tr_b16 v[212:213], v233 offset:4096
    v_cvt_pk_bf16_f32 v107, v118, v119
    ds_read_b64_tr_b16 v[214:215], v233 offset:6144
    ds_read_b64_tr_b16 v[216:217], v234 offset:4096
    ds_read_b64_tr_b16 v[218:219], v234 offset:6144
    ds_read_b64_tr_b16 v[220:221], v235 offset:4096
    ds_read_b64_tr_b16 v[222:223], v235 offset:6144
    v_mfma_f32_32x32x16_bf16 v[0:15], v[192:195], v[96:99], 0
    ds_read_b64_tr_b16 v[192:193], v232 offset:8192
    s_waitcnt lgkmcnt(13)
    ds_read_b64_tr_b16 v[194:195], v232 offset:10240
    v_exp_f32 v120, v120
    v_mfma_f32_32x32x16_bf16 v[16:31], v[196:199], v[96:99], 0
    ds_read_b64_tr_b16 v[196:197], v233 offset:8192
    s_waitcnt lgkmcnt(13)
    ds_read_b64_tr_b16 v[198:199], v233 offset:10240
    v_exp_f32 v121, v121
    v_mfma_f32_32x32x16_bf16 v[32:47], v[200:203], v[96:99], 0
    ds_read_b64_tr_b16 v[200:201], v234 offset:8192
    s_waitcnt lgkmcnt(13)
    ds_read_b64_tr_b16 v[202:203], v234 offset:10240
    v_exp_f32 v122, v122
    v_mfma_f32_32x32x16_bf16 v[48:63], v[204:207], v[96:99], 0
    ds_read_b64_tr_b16 v[204:205], v235 offset:8192
    s_waitcnt lgkmcnt(13)
    ds_read_b64_tr_b16 v[206:207], v235 offset:10240
    v_exp_f32 v123, v123
    v_mfma_f32_16x16x32_bf16 v[238:241], v[246:249], v[96:99], v[238:241]
    v_cvt_pk_bf16_f32 v108, v120, v121
    v_cvt_pk_bf16_f32 v109, v122, v123
    v_mfma_f32_32x32x16_bf16 v[0:15], v[208:211], v[100:103], v[0:15]
    ds_read_b64_tr_b16 v[208:209], v232 offset:12288
    s_waitcnt lgkmcnt(13)
    ds_read_b64_tr_b16 v[210:211], v232 offset:14336
    v_exp_f32 v124, v124
    v_mfma_f32_32x32x16_bf16 v[16:31], v[212:215], v[100:103], v[16:31]
    ds_read_b64_tr_b16 v[212:213], v233 offset:12288
    s_waitcnt lgkmcnt(13)
    ds_read_b64_tr_b16 v[214:215], v233 offset:14336
    v_exp_f32 v125, v125
    v_mfma_f32_32x32x16_bf16 v[32:47], v[216:219], v[100:103], v[32:47]
    ds_read_b64_tr_b16 v[216:217], v234 offset:12288
    s_waitcnt lgkmcnt(13)
    ds_read_b64_tr_b16 v[218:219], v234 offset:14336
    v_exp_f32 v126, v126
    v_mfma_f32_32x32x16_bf16 v[48:63], v[220:223], v[100:103], v[48:63]
    ds_read_b64_tr_b16 v[220:221], v235 offset:12288
    s_waitcnt lgkmcnt(13)
    ds_read_b64_tr_b16 v[222:223], v235 offset:14336
    v_exp_f32 v127, v127
    v_mfma_f32_16x16x32_bf16 v[238:241], v[246:249], v[100:103], v[238:241]
    v_cvt_pk_bf16_f32 v110, v124, v125
    v_cvt_pk_bf16_f32 v111, v126, v127
    s_mov_b32 s27, 3
L1_loop:
    s_waitcnt vmcnt(6)
    s_barrier
    s_add_u32 m0, s24, 114688
    s_nop 0
    buffer_load_dwordx4 v237, s[8:11], s30 offen nt lds
    s_add_u32 m0, s24, 122880
    s_nop 0
    buffer_load_dwordx4 v237, s[8:11], s31 offen nt lds
    s_add_u32 m0, s24, 0
    s_nop 0
    buffer_load_dwordx4 v236, s[4:7], s28 offen nt lds
    s_add_u32 m0, s24, 8192
    s_nop 0
    buffer_load_dwordx4 v236, s[4:7], s29 offen nt lds
    s_add_u32 s28, s28, 16384
    s_add_u32 s29, s29, 16384
    s_add_u32 s30, s30, 16384
    s_add_u32 s31, s31, 16384
    ds_read_b128 v[160:163], v224 offset:16384
    s_waitcnt lgkmcnt(13)
    ds_read_b128 v[164:167], v225 offset:16384
    ds_read_b128 v[168:171], v226 offset:16384
    s_waitcnt lgkmcnt(13)
    ds_read_b128 v[172:175], v227 offset:16384
    v_mfma_f32_32x32x16_bf16 v[0:15], v[192:195], v[104:107], v[0:15]
    v_max3_f32 v242, v128, v129, v130
    v_max3_f32 v244, v131, v132, v133
    v_mfma_f32_32x32x16_bf16 v[16:31], v[196:199], v[104:107], v[16:31]
    v_max3_f32 v242, v242, v134, v135
    v_max3_f32 v244, v244, v136, v137
    v_mfma_f32_32x32x16_bf16 v[32:47], v[200:203], v[104:107], v[32:47]
    v_max3_f32 v242, v242, v138, v139
    v_max3_f32 v244, v244, v140, v141
    s_waitcnt lgkmcnt(12)
    v_mfma_f32_32x32x16_bf16 v[48:63], v[204:207], v[104:107], v[48:63]
    v_max3_f32 v242, v242, v142, v143
    v_max3_f32 v244, v244, v144, v145
    v_mfma_f32_16x16x32_bf16 v[238:241], v[246:249], v[104:107], v[238:241]
    v_max3_f32 v242, v242, v146, v147
    v_max3_f32 v244, v244, v148, v149
    s_waitcnt lgkmcnt(10)
    v_mfma_f32_32x32x16_bf16 v[0:15], v[208:211], v[108:111], v[0:15]
    v_max3_f32 v242, v242, v150, v151
    v_max3_f32 v244, v244, v152, v153
    s_waitcnt lgkmcnt(8)
    v_mfma_f32_32x32x16_bf16 v[16:31], v[212:215], v[108:111], v[16:31]
    v_max3_f32 v242, v242, v154, v155
    v_max3_f32 v244, v244, v156, v157
    s_waitcnt lgkmcnt(6)
    v_mfma_f32_32x32x16_bf16 v[32:47], v[216:219], v[108:111], v[32:47]
    v_max3_f32 v242, v242, v158, v159
    v_max_f32 v242, v242, v244
    s_waitcnt lgkmcnt(4)
    v_mfma_f32_32x32x16_bf16 v[48:63], v[220:223], v[108:111], v[48:63]
    v_mov_b32 v243, v242
    s_nop 1
    v_permlane32_swap_b32 v242, v243
    v_mfma_f32_16x16x32_bf16 v[238:241], v[246:249], v[108:111], v[238:241]
    v_max_f32 v242, v242, v243
    v_cmp_lt_f32 vcc, s26, v242
    s_cbranch_vccnz L1_rare1
L1_back1:
    s_waitcnt lgkmcnt(3)
    v_mfma_f32_32x32x16_bf16 v[96:111], v[160:163], v[64:67], v[176:191]
    ds_read_b128 v[160:163], v228 offset:16384
    v_exp_f32 v128, v128
    v_exp_f32 v129, v129
    s_waitcnt lgkmcnt(3)
    v_mfma_f32_32x32x16_bf16 v[96:111], v[164:167], v[68:71], v[96:111]
    ds_read_b128 v[164:167], v229 offset:16384
    v_exp_f32 v130, v130
    v_exp_f32 v131, v131
    v_cvt_pk_bf16_f32 v128, v128, v129
    s_waitcnt lgkmcnt(3)
    v_mfma_f32_32x32x16_bf16 v[96:111], v[168:171], v[72:75], v[96:111]
    ds_read_b128 v[168:171], v230 offset:16384
    v_cvt_pk_bf16_f32 v129, v130, v131
    v_exp_f32 v132, v132
    s_waitcnt lgkmcnt(3)
    v_mfma_f32_32x32x16_bf16 v[96:111], v[172:175], v[76:79], v[96:111]
    ds_read_b128 v[172:175], v231 offset:16384
    v_exp_f32 v133, v133
    v_exp_f32 v134, v134
    v_exp_f32 v135, v135
    s_waitcnt lgkmcnt(3)
    v_mfma_f32_32x32x16_bf16 v[96:111], v[160:163], v[80:83], v[96:111]
    ds_read_b128 v[160:163], v224 offset:24576
    v_cvt_pk_bf16_f32 v130, v132, v133
    v_cvt_pk_bf16_f32 v131, v134, v135
    v_exp_f32 v136, v136
    s_waitcnt lgkmcnt(3)
    v_mfma_f32_32x32x16_bf16 v[96:111], v[164:167], v[84:87], v[96:111]
    ds_read_b128 v[164:167], v225 offset:24576
    v_exp_f32 v137, v137
    v_exp_f32 v138, v138
    s_waitcnt lgkmcnt(3)
    v_mfma_f32_32x32x16_bf16 v[96:111], v[168:171], v[88:91], v[96:111]
    ds_read_b128 v[168:171], v226 offset:24576
    v_exp_f32 v139, v139
    v_cvt_pk_bf16_f32 v132, v136, v137
    v_cvt_pk_bf16_f32 v133, v138, v139
    s_waitcnt lgkmcnt(3)
    v_mfma_f32_32x32x16_bf16 v[96:111], v[172:175], v[92:95], v[96:111]
    ds_read_b128 v[172:175], v227 offset:24576
    v_exp_f32 v140, v140
    v_exp_f32 v141, v141
    s_waitcnt lgkmcnt(3)
    v_mfma_f32_32x32x16_bf16 v[112:127], v[160:163], v[64:67], v[176:191]
    ds_read_b128 v[160:163], v228 offset:24576
    v_exp_f32 v142, v142
    v_exp_f32 v143, v143
    s_waitcnt lgkmcnt(3)
    v_mfma_f32_32x32x16_bf16 v[112:127], v[164:167], v[68:71], v[112:127]
    ds_read_b128 v[164:167], v229 offset:24576
    v_cvt_pk_bf16_f32 v134, v140, v141
    v_cvt_pk_bf16_f32 v135, v142, v143
    v_exp_f32 v144, v144
    ds_read_b64_tr_b16 v[192:193], v232 offset:16384
    s_waitcnt lgkmcnt(4)
    v_mfma_f32_32x32x16_bf16 v[112:127], v[168:171], v[72:75], v[112:127]
    ds_read_b128 v[168:171], v230 offset:24576
    v_exp_f32 v145, v145
    ds_read_b64_tr_b16 v[194:195], v232 offset:18432
    v_exp_f32 v146, v146
    s_waitcnt lgkmcnt(5)
    v_mfma_f32_32x32x16_bf16 v[112:127], v[172:175], v[76:79], v[112:127]
    ds_read_b128 v[172:175], v231 offset:24576
    ds_read_b64_tr_b16 v[196:197], v233 offset:16384
    v_exp_f32 v147, v147
    ds_read_b64_tr_b16 v[198:199], v233 offset:18432
    v_cvt_pk_bf16_f32 v136, v144, v145
    s_waitcnt lgkmcnt(7)
    v_mfma_f32_32x32x16_bf16 v[112:127], v[160:163], v[80:83], v[112:127]
    ds_read_b64_tr_b16 v[200:201], v234 offset:16384
    v_cvt_pk_bf16_f32 v137, v146, v147
    ds_read_b64_tr_b16 v[202:203], v234 offset:18432
    v_exp_f32 v148, v148
    ds_read_b64_tr_b16 v[204:205], v235 offset:16384
    s_waitcnt lgkmcnt(9)
    v_mfma_f32_32x32x16_bf16 v[112:127], v[164:167], v[84:87], v[112:127]
    v_exp_f32 v149, v149
    ds_read_b64_tr_b16 v[206:207], v235 offset:18432
    v_exp_f32 v150, v150
    s_waitcnt lgkmcnt(8)
    v_mfma_f32_32x32x16_bf16 v[112:127], v[168:171], v[88:91], v[112:127]
    ds_read_b64_tr_b16 v[208:209], v232 offset:20480
    v_exp_f32 v151, v151
    ds_read_b64_tr_b16 v[210:211], v232 offset:22528
    v_cvt_pk_bf16_f32 v138, v148, v149
    s_waitcnt lgkmcnt(8)
    v_mfma_f32_32x32x16_bf16 v[112:127], v[172:175], v[92:95], v[112:127]
    ds_read_b64_tr_b16 v[212:213], v233 offset:20480
    v_cvt_pk_bf16_f32 v139, v150, v151
    ds_read_b64_tr_b16 v[214:215], v233 offset:22528
    ds_read_b64_tr_b16 v[216:217], v234 offset:20480
    ds_read_b64_tr_b16 v[218:219], v234 offset:22528
    ds_read_b64_tr_b16 v[220:221], v235 offset:20480
    ds_read_b64_tr_b16 v[222:223], v235 offset:22528
    v_mfma_f32_32x32x16_bf16 v[0:15], v[192:195], v[128:131], v[0:15]
    ds_read_b64_tr_b16 v[192:193], v232 offset:24576
    s_waitcnt lgkmcnt(13)
    ds_read_b64_tr_b16 v[194:195], v232 offset:26624
    v_exp_f32 v152, v152
    v_mfma_f32_32x32x16_bf16 v[16:31], v[196:199], v[128:131], v[16:31]
    ds_read_b64_tr_b16 v[196:197], v233 offset:24576
    s_waitcnt lgkmcnt(13)
    ds_read_b64_tr_b16 v[198:199], v233 offset:26624
    v_exp_f32 v153, v153
    v_mfma_f32_32x32x16_bf16 v[32:47], v[200:203], v[128:131], v[32:47]
    ds_read_b64_tr_b16 v[200:201], v234 offset:24576
    s_waitcnt lgkmcnt(13)
    ds_read_b64_tr_b16 v[202:203], v234 offset:26624
    v_exp_f32 v154, v154
    v_mfma_f32_32x32x16_bf16 v[48:63], v[204:207], v[128:131], v[48:63]
    ds_read_b64_tr_b16 v[204:205], v235 offset:24576
    s_waitcnt lgkmcnt(13)
    ds_read_b64_tr_b16 v[206:207], v235 offset:26624
    v_exp_f32 v155, v155
    v_mfma_f32_16x16x32_bf16 v[238:241], v[246:249], v[128:131], v[238:241]
    v_cvt_pk_bf16_f32 v140, v152, v153
    v_cvt_pk_bf16_f32 v141, v154, v155
    v_mfma_f32_32x32x16_bf16 v[0:15], v[208:211], v[132:135], v[0:15]
    ds_read_b64_tr_b16 v[208:209], v232 offset:28672
    s_waitcnt lgkmcnt(13)
    ds_read_b64_tr_b16 v[210:211], v232 offset:30720
    v_exp_f32 v156, v156
    v_mfma_f32_32x32x16_bf16 v[16:31], v[212:215], v[132:135], v[16:31]
    ds_read_b64_tr_b16 v[212:213], v233 offset:28672
    s_waitcnt lgkmcnt(13)
    ds_read_b64_tr_b16 v[214:215], v233 offset:30720
    v_exp_f32 v157, v157
    v_mfma_f32_32x32x16_bf16 v[32:47], v[216:219], v[132:135], v[32:47]
    ds_read_b64_tr_b16 v[216:217], v234 offset:28672
    s_waitcnt lgkmcnt(13)
    ds_read_b64_tr_b16 v[218:219], v234 offset:30720
    v_exp_f32 v158, v158
    v_mfma_f32_32x32x16_bf16 v[48:63], v[220:223], v[132:135], v[48:63]
    ds_read_b64_tr_b16 v[220:221], v235 offset:28672
    s_waitcnt lgkmcnt(13)
    ds_read_b64_tr_b16 v[222:223], v235 offset:30720
    v_exp_f32 v159, v159
    v_mfma_f32_16x16x32_bf16 v[238:241], v[246:249], v[132:135], v[238:241]
    v_cvt_pk_bf16_f32 v142, v156, v157
    v_cvt_pk_bf16_f32 v143, v158, v159
    s_waitcnt vmcnt(6)
    s_barrier
    s_add_u32 m0, s24, 65536
    s_nop 0
    buffer_load_dwordx4 v237, s[8:11], s30 offen nt lds
    s_add_u32 m0, s24, 73728
    s_nop 0
    buffer_load_dwordx4 v237, s[8:11], s31 offen nt lds
    s_add_u32 m0, s24, 16384
    s_nop 0
    buffer_load_dwordx4 v236, s[4:7], s28 offen nt lds
    s_add_u32 m0, s24, 24576
    s_nop 0
    buffer_load_dwordx4 v236, s[4:7], s29 offen nt lds
    s_add_u32 s28, s28, 16384
    s_add_u32 s29, s29, 16384
    s_add_u32 s30, s30, 16384
    s_add_u32 s31, s31, 16384
    ds_read_b128 v[160:163], v224 offset:32768
    s_waitcnt lgkmcnt(13)
    ds_read_b128 v[164:167], v225 offset:32768
    ds_read_b128 v[168:171], v226 offset:32768
    s_waitcnt lgkmcnt(13)
    ds_read_b128 v[172:175], v227 offset:32768
    v_mfma_f32_32x32x16_bf16 v[0:15], v[192:195], v[136:139], v[0:15]
    v_max3_f32 v242, v96, v97, v98
    v_max3_f32 v244, v99, v100, v101
    v_mfma_f32_32x32x16_bf16 v[16:31], v[196:199], v[136:139], v[16:31]
    v_max3_f32 v242, v242, v102, v103
    v_max3_f32 v244, v244, v104, v105
    v_mfma_f32_32x32x16_bf16 v[32:47], v[200:203], v[136:139], v[32:47]
    v_max3_f32 v242, v242, v106, v107
    v_max3_f32 v244, v244, v108, v109
    s_waitcnt lgkmcnt(12)
    v_mfma_f32_32x32x16_bf16 v[48:63], v[204:207], v[136:139], v[48:63]
    v_max3_f32 v242, v242, v110, v111
    v_max3_f32 v244, v244, v112, v113
    v_mfma_f32_16x16x32_bf16 v[238:241], v[246:249], v[136:139], v[238:241]
    v_max3_f32 v242, v242, v114, v115
    v_max3_f32 v244, v244, v116, v117
    s_waitcnt lgkmcnt(10)
    v_mfma_f32_32x32x16_bf16 v[0:15], v[208:211], v[140:143], v[0:15]
    v_max3_f32 v242, v242, v118, v119
    v_max3_f32 v244, v244, v120, v121
    s_waitcnt lgkmcnt(8)
    v_mfma_f32_32x32x16_bf16 v[16:31], v[212:215], v[140:143], v[16:31]
    v_max3_f32 v242, v242, v122, v123
    v_max3_f32 v244, v244, v124, v125
    s_waitcnt lgkmcnt(6)
    v_mfma_f32_32x32x16_bf16 v[32:47], v[216:219], v[140:143], v[32:47]
    v_max3_f32 v242, v242, v126, v127
    v_max_f32 v242, v242, v244
    s_waitcnt lgkmcnt(4)
    v_mfma_f32_32x32x16_bf16 v[48:63], v[220:223], v[140:143], v[48:63]
    v_mov_b32 v243, v242
    s_nop 1
    v_permlane32_swap_b32 v242, v243
    v_mfma_f32_16x16x32_bf16 v[238:241], v[246:249], v[140:143], v[238:241]
    v_max_f32 v242, v242, v243
    v_cmp_lt_f32 vcc, s26, v242
    s_cbranch_vccnz L1_rare2
L1_back2:
    s_waitcnt lgkmcnt(3)
    v_mfma_f32_32x32x16_bf16 v[128:143], v[160:163], v[64:67], v[176:191]
    ds_read_b128 v[160:163], v228 offset:32768
    v_exp_f32 v96, v96
    v_exp_f32 v97, v97
    s_waitcnt lgkmcnt(3)
    v_mfma_f32_32x32x16_bf16 v[128:143], v[164:167], v[68:71], v[128:143]
    ds_read_b128 v[164:167], v229 offset:32768
    v_exp_f32 v98, v98
    v_exp_f32 v99, v99
    v_cvt_pk_bf16_f32 v96, v96, v97
    s_waitcnt lgkmcnt(3)
    v_mfma_f32_32x32x16_bf16 v[128:143], v[168:171], v[72:75], v[128:143]
    ds_read_b128 v[168:171], v230 offset:32768
    v_cvt_pk_bf16_f32 v97, v98, v99
    v_exp_f32 v100, v100
    s_waitcnt lgkmcnt(3)
    v_mfma_f32_32x32x16_bf16 v[128:143], v[172:175], v[76:79], v[128:143]
    ds_read_b128 v[172:175], v231 offset:32768
    v_exp_f32 v101, v101
    v_exp_f32 v102, v102
    v_exp_f32 v103, v103
    s_waitcnt lgkmcnt(3)
    v_mfma_f32_32x32x16_bf16 v[128:143], v[160:163], v[80:83], v[128:143]
    ds_read_b128 v[160:163], v224 offset:40960
    v_cvt_pk_bf16_f32 v98, v100, v101
    v_cvt_pk_bf16_f32 v99, v102, v103
    v_exp_f32 v104, v104
    s_waitcnt lgkmcnt(3)
    v_mfma_f32_32x32x16_bf16 v[128:143], v[164:167], v[84:87], v[128:143]
    ds_read_b128 v[164:167], v225 offset:40960
    v_exp_f32 v105, v105
    v_exp_f32 v106, v106
    s_waitcnt lgkmcnt(3)
    v_mfma_f32_32x32x16_bf16 v[128:143], v[168:171], v[88:91], v[128:143]
    ds_read_b128 v[168:171], v226 offset:40960
    v_exp_f32 v107, v107
    v_cvt_pk_bf16_f32 v100, v104, v105
    v_cvt_pk_bf16_f32 v101, v106, v107
    s_waitcnt lgkmcnt(3)
    v_mfma_f32_32x32x16_bf16 v[128:143], v[172:175], v[92:95], v[128:143]
    ds_read_b128 v[172:175], v227 offset:40960
    v_exp_f32 v108, v108
    v_exp_f32 v109, v109
    s_waitcnt lgkmcnt(3)
    v_mfma_f32_32x32x16_bf16 v[144:159], v[160:163], v[64:67], v[176:191]
    ds_read_b128 v[160:163], v228 offset:40960
    v_exp_f32 v110, v110
    v_exp_f32 v111, v111
    s_waitcnt lgkmcnt(3)
    v_mfma_f32_32x32x16_bf16 v[144:159], v[164:167], v[68:71], v[144:159]
    ds_read_b128 v[164:167], v229 offset:40960
    v_cvt_pk_bf16_f32 v102, v108, v109
    v_cvt_pk_bf16_f32 v103, v110, v111
    v_exp_f32 v112, v112
    ds_read_b64_tr_b16 v[192:193], v232 offset:32768
    s_waitcnt lgkmcnt(4)
    v_mfma_f32_32x32x16_bf16 v[144:159], v[168:171], v[72:75], v[144:159]
    ds_read_b128 v[168:171], v230 offset:40960
    v_exp_f32 v113, v113
    ds_read_b64_tr_b16 v[194:195], v232 offset:34816
    v_exp_f32 v114, v114
    s_waitcnt lgkmcnt(5)
    v_mfma_f32_32x32x16_bf16 v[144:159], v[172:175], v[76:79], v[144:159]
    ds_read_b128 v[172:175], v231 offset:40960
    ds_read_b64_tr_b16 v[196:197], v233 offset:32768
    v_exp_f32 v115, v115
    ds_read_b64_tr_b16 v[198:199], v233 offset:34816
    v_cvt_pk_bf16_f32 v104, v112, v113
    s_waitcnt lgkmcnt(7)
    v_mfma_f32_32x32x16_bf16 v[144:159], v[160:163], v[80:83], v[144:159]
    ds_read_b64_tr_b16 v[200:201], v234 offset:32768
    v_cvt_pk_bf16_f32 v105, v114, v115
    ds_read_b64_tr_b16 v[202:203], v234 offset:34816
    v_exp_f32 v116, v116
    ds_read_b64_tr_b16 v[204:205], v235 offset:32768
    s_waitcnt lgkmcnt(9)
    v_mfma_f32_32x32x16_bf16 v[144:159], v[164:167], v[84:87], v[144:159]
    v_exp_f32 v117, v117
    ds_read_b64_tr_b16 v[206:207], v235 offset:34816
    v_exp_f32 v118, v118
    s_waitcnt lgkmcnt(8)
    v_mfma_f32_32x32x16_bf16 v[144:159], v[168:171], v[88:91], v[144:159]
    ds_read_b64_tr_b16 v[208:209], v232 offset:36864
    v_exp_f32 v119, v119
    ds_read_b64_tr_b16 v[210:211], v232 offset:38912
    v_cvt_pk_bf16_f32 v106, v116, v117
    s_waitcnt lgkmcnt(8)
    v_mfma_f32_32x32x16_bf16 v[144:159], v[172:175], v[92:95], v[144:159]
    ds_read_b64_tr_b16 v[212:213], v233 offset:36864
    v_cvt_pk_bf16_f32 v107, v118, v119
    ds_read_b64_tr_b16 v[214:215], v233 offset:38912
    ds_read_b64_tr_b16 v[216:217], v234 offset:36864
    ds_read_b64_tr_b16 v[218:219], v234 offset:38912
    ds_read_b64_tr_b16 v[220:221], v235 offset:36864
    ds_read_b64_tr_b16 v[222:223], v235 offset:38912
    v_mfma_f32_32x32x16_bf16 v[0:15], v[192:195], v[96:99], v[0:15]
    ds_read_b64_tr_b16 v[192:193], v232 offset:40960
    s_waitcnt lgkmcnt(13)
    ds_read_b64_tr_b16 v[194:195], v232 offset:43008
    v_exp_f32 v120, v120
    v_mfma_f32_32x32x16_bf16 v[16:31], v[196:199], v[96:99], v[16:31]
    ds_read_b64_tr_b16 v[196:197], v233 offset:40960
    s_waitcnt lgkmcnt(13)
    ds_read_b64_tr_b16 v[198:199], v233 offset:43008
    v_exp_f32 v121, v121
    v_mfma_f32_32x32x16_bf16 v[32:47], v[200:203], v[96:99], v[32:47]
    ds_read_b64_tr_b16 v[200:201], v234 offset:40960
    s_waitcnt lgkmcnt(13)
    ds_read_b64_tr_b16 v[202:203], v234 offset:43008
    v_exp_f32 v122, v122
    v_mfma_f32_32x32x16_bf16 v[48:63], v[204:207], v[96:99], v[48:63]
    ds_read_b64_tr_b16 v[204:205], v235 offset:40960
    s_waitcnt lgkmcnt(13)
    ds_read_b64_tr_b16 v[206:207], v235 offset:43008
    v_exp_f32 v123, v123
    v_mfma_f32_16x16x32_bf16 v[238:241], v[246:249], v[96:99], v[238:241]
    v_cvt_pk_bf16_f32 v108, v120, v121
    v_cvt_pk_bf16_f32 v109, v122, v123
    v_mfma_f32_32x32x16_bf16 v[0:15], v[208:211], v[100:103], v[0:15]
    ds_read_b64_tr_b16 v[208:209], v232 offset:45056
    s_waitcnt lgkmcnt(13)
    ds_read_b64_tr_b16 v[210:211], v232 offset:47104
    v_exp_f32 v124, v124
    v_mfma_f32_32x32x16_bf16 v[16:31], v[212:215], v[100:103], v[16:31]
    ds_read_b64_tr_b16 v[212:213], v233 offset:45056
    s_waitcnt lgkmcnt(13)
    ds_read_b64_tr_b16 v[214:215], v233 offset:47104
    v_exp_f32 v125, v125
    v_mfma_f32_32x32x16_bf16 v[32:47], v[216:219], v[100:103], v[32:47]
    ds_read_b64_tr_b16 v[216:217], v234 offset:45056
    s_waitcnt lgkmcnt(13)
    ds_read_b64_tr_b16 v[218:219], v234 offset:47104
    v_exp_f32 v126, v126
    v_mfma_f32_32x32x16_bf16 v[48:63], v[220:223], v[100:103], v[48:63]
    ds_read_b64_tr_b16 v[220:221], v235 offset:45056
    s_waitcnt lgkmcnt(13)
    ds_read_b64_tr_b16 v[222:223], v235 offset:47104
    v_exp_f32 v127, v127
    v_mfma_f32_16x16x32_bf16 v[238:241], v[246:249], v[100:103], v[238:241]
    v_cvt_pk_bf16_f32 v110, v124, v125
    v_cvt_pk_bf16_f32 v111, v126, v127
    s_waitcnt vmcnt(6)
    s_barrier
    s_add_u32 m0, s24, 81920
    s_nop 0
    buffer_load_dwordx4 v237, s[8:11], s30 offen nt lds
    s_add_u32 m0, s24, 90112
    s_nop 0
    buffer_load_dwordx4 v237, s[8:11], s31 offen nt lds
    s_add_u32 m0, s24, 32768
    s_nop 0
    buffer_load_dwordx4 v236, s[4:7], s28 offen nt lds
    s_add_u32 m0, s24, 40960
    s_nop 0
    buffer_load_dwordx4 v236, s[4:7], s29 offen nt lds
    s_add_u32 s28, s28, 16384
    s_add_u32 s29, s29, 16384
    s_add_u32 s30, s30, 16384
    s_add_u32 s31, s31, 16384
    ds_read_b128 v[160:163], v224 offset:49152
    s_waitcnt lgkmcnt(13)
    ds_read_b128 v[164:167], v225 offset:49152
    ds_read_b128 v[168:171], v226 offset:49152
    s_waitcnt lgkmcnt(13)
    ds_read_b128 v[172:175], v227 offset:49152
    v_mfma_f32_32x32x16_bf16 v[0:15], v[192:195], v[104:107], v[0:15]
    v_max3_f32 v242, v128, v129, v130
    v_max3_f32 v244, v131, v132, v133
    v_mfma_f32_32x32x16_bf16 v[16:31], v[196:199], v[104:107], v[16:31]
    v_max3_f32 v242, v242, v134, v135
    v_max3_f32 v244, v244, v136, v137
    v_mfma_f32_32x32x16_bf16 v[32:47], v[200:203], v[104:107], v[32:47]
    v_max3_f32 v242, v242, v138, v139
    v_max3_f32 v244, v244, v140, v141
    s_waitcnt lgkmcnt(12)
    v_mfma_f32_32x32x16_bf16 v[48:63], v[204:207], v[104:107], v[48:63]
    v_max3_f32 v242, v242, v142, v143
    v_max3_f32 v244, v244, v144, v145
    v_mfma_f32_16x16x32_bf16 v[238:241], v[246:249], v[104:107], v[238:241]
    v_max3_f32 v242, v242, v146, v147
    v_max3_f32 v244, v244, v148, v149
    s_waitcnt lgkmcnt(10)
    v_mfma_f32_32x32x16_bf16 v[0:15], v[208:211], v[108:111], v[0:15]
    v_max3_f32 v242, v242, v150, v151
    v_max3_f32 v244, v244, v152, v153
    s_waitcnt lgkmcnt(8)
    v_mfma_f32_32x32x16_bf16 v[16:31], v[212:215], v[108:111], v[16:31]
    v_max3_f32 v242, v242, v154, v155
    v_max3_f32 v244, v244, v156, v157
    s_waitcnt lgkmcnt(6)
    v_mfma_f32_32x32x16_bf16 v[32:47], v[216:219], v[108:111], v[32:47]
    v_max3_f32 v242, v242, v158, v159
    v_max_f32 v242, v242, v244
    s_waitcnt lgkmcnt(4)
    v_mfma_f32_32x32x16_bf16 v[48:63], v[220:223], v[108:111], v[48:63]
    v_mov_b32 v243, v242
    s_nop 1
    v_permlane32_swap_b32 v242, v243
    v_mfma_f32_16x16x32_bf16 v[238:241], v[246:249], v[108:111], v[238:241]
    v_max_f32 v242, v242, v243
    v_cmp_lt_f32 vcc, s26, v242
    s_cbranch_vccnz L1_rare3
L1_back3:
    s_waitcnt lgkmcnt(3)
    v_mfma_f32_32x32x16_bf16 v[96:111], v[160:163], v[64:67], v[176:191]
    ds_read_b128 v[160:163], v228 offset:49152
    v_exp_f32 v128, v128
    v_exp_f32 v129, v129
    s_waitcnt lgkmcnt(3)
    v_mfma_f32_32x32x16_bf16 v[96:111], v[164:167], v[68:71], v[96:111]
    ds_read_b128 v[164:167], v229 offset:49152
    v_exp_f32 v130, v130
    v_exp_f32 v131, v131
    v_cvt_pk_bf16_f32 v128, v128, v129
    s_waitcnt lgkmcnt(3)
    v_mfma_f32_32x32x16_bf16 v[96:111], v[168:171], v[72:75], v[96:111]
    ds_read_b128 v[168:171], v230 offset:49152
    v_cvt_pk_bf16_f32 v129, v130, v131
    v_exp_f32 v132, v132
    s_waitcnt lgkmcnt(3)
    v_mfma_f32_32x32x16_bf16 v[96:111], v[172:175], v[76:79], v[96:111]
    ds_read_b128 v[172:175], v231 offset:49152
    v_exp_f32 v133, v133
    v_exp_f32 v134, v134
    v_exp_f32 v135, v135
    s_waitcnt lgkmcnt(3)
    v_mfma_f32_32x32x16_bf16 v[96:111], v[160:163], v[80:83], v[96:111]
    ds_read_b128 v[160:163], v224 offset:57344
    v_cvt_pk_bf16_f32 v130, v132, v133
    v_cvt_pk_bf16_f32 v131, v134, v135
    v_exp_f32 v136, v136
    s_waitcnt lgkmcnt(3)
    v_mfma_f32_32x32x16_bf16 v[96:111], v[164:167], v[84:87], v[96:111]
    ds_read_b128 v[164:167], v225 offset:57344
    v_exp_f32 v137, v137
    v_exp_f32 v138, v138
    s_waitcnt lgkmcnt(3)
    v_mfma_f32_32x32x16_bf16 v[96:111], v[168:171], v[88:91], v[96:111]
    ds_read_b128 v[168:171], v226 offset:57344
    v_exp_f32 v139, v139
    v_cvt_pk_bf16_f32 v132, v136, v137
    v_cvt_pk_bf16_f32 v133, v138, v139
    s_waitcnt lgkmcnt(3)
    v_mfma_f32_32x32x16_bf16 v[96:111], v[172:175], v[92:95], v[96:111]
    ds_read_b128 v[172:175], v227 offset:57344
    v_exp_f32 v140, v140
    v_exp_f32 v141, v141
    s_waitcnt lgkmcnt(3)
    v_mfma_f32_32x32x16_bf16 v[112:127], v[160:163], v[64:67], v[176:191]
    ds_read_b128 v[160:163], v228 offset:57344
    v_exp_f32 v142, v142
    v_exp_f32 v143, v143
    s_waitcnt lgkmcnt(3)
    v_mfma_f32_32x32x16_bf16 v[112:127], v[164:167], v[68:71], v[112:127]
    ds_read_b128 v[164:167], v229 offset:57344
    v_cvt_pk_bf16_f32 v134, v140, v141
    v_cvt_pk_bf16_f32 v135, v142, v143
    v_exp_f32 v144, v144
    ds_read_b64_tr_b16 v[192:193], v232 offset:49152
    s_waitcnt lgkmcnt(4)
    v_mfma_f32_32x32x16_bf16 v[112:127], v[168:171], v[72:75], v[112:127]
    ds_read_b128 v[168:171], v230 offset:57344
    v_exp_f32 v145, v145
    ds_read_b64_tr_b16 v[194:195], v232 offset:51200
    v_exp_f32 v146, v146
    s_waitcnt lgkmcnt(5)
    v_mfma_f32_32x32x16_bf16 v[112:127], v[172:175], v[76:79], v[112:127]
    ds_read_b128 v[172:175], v231 offset:57344
    ds_read_b64_tr_b16 v[196:197], v233 offset:49152
    v_exp_f32 v147, v147
    ds_read_b64_tr_b16 v[198:199], v233 offset:51200
    v_cvt_pk_bf16_f32 v136, v144, v145
    s_waitcnt lgkmcnt(7)
    v_mfma_f32_32x32x16_bf16 v[112:127], v[160:163], v[80:83], v[112:127]
    ds_read_b64_tr_b16 v[200:201], v234 offset:49152
    v_cvt_pk_bf16_f32 v137, v146, v147
    ds_read_b64_tr_b16 v[202:203], v234 offset:51200
    v_exp_f32 v148, v148
    ds_read_b64_tr_b16 v[204:205], v235 offset:49152
    s_waitcnt lgkmcnt(9)
    v_mfma_f32_32x32x16_bf16 v[112:127], v[164:167], v[84:87], v[112:127]
    v_exp_f32 v149, v149
    ds_read_b64_tr_b16 v[206:207], v235 offset:51200
    v_exp_f32 v150, v150
    s_waitcnt lgkmcnt(8)
    v_mfma_f32_32x32x16_bf16 v[112:127], v[168:171], v[88:91], v[112:127]
    ds_read_b64_tr_b16 v[208:209], v232 offset:53248
    v_exp_f32 v151, v151
    ds_read_b64_tr_b16 v[210:211], v232 offset:55296
    v_cvt_pk_bf16_f32 v138, v148, v149
    s_waitcnt lgkmcnt(8)
    v_mfma_f32_32x32x16_bf16 v[112:127], v[172:175], v[92:95], v[112:127]
    ds_read_b64_tr_b16 v[212:213], v233 offset:53248
    v_cvt_pk_bf16_f32 v139, v150, v151
    ds_read_b64_tr_b16 v[214:215], v233 offset:55296
    ds_read_b64_tr_b16 v[216:217], v234 offset:53248
    ds_read_b64_tr_b16 v[218:219], v234 offset:55296
    ds_read_b64_tr_b16 v[220:221], v235 offset:53248
    ds_read_b64_tr_b16 v[222:223], v235 offset:55296
    v_mfma_f32_32x32x16_bf16 v[0:15], v[192:195], v[128:131], v[0:15]
    ds_read_b64_tr_b16 v[192:193], v232 offset:57344
    s_waitcnt lgkmcnt(13)
    ds_read_b64_tr_b16 v[194:195], v232 offset:59392
    v_exp_f32 v152, v152
    v_mfma_f32_32x32x16_bf16 v[16:31], v[196:199], v[128:131], v[16:31]
    ds_read_b64_tr_b16 v[196:197], v233 offset:57344
    s_waitcnt lgkmcnt(13)
    ds_read_b64_tr_b16 v[198:199], v233 offset:59392
    v_exp_f32 v153, v153
    v_mfma_f32_32x32x16_bf16 v[32:47], v[200:203], v[128:131], v[32:47]
    ds_read_b64_tr_b16 v[200:201], v234 offset:57344
    s_waitcnt lgkmcnt(13)
    ds_read_b64_tr_b16 v[202:203], v234 offset:59392
    v_exp_f32 v154, v154
    v_mfma_f32_32x32x16_bf16 v[48:63], v[204:207], v[128:131], v[48:63]
    ds_read_b64_tr_b16 v[204:205], v235 offset:57344
    s_waitcnt lgkmcnt(13)
    ds_read_b64_tr_b16 v[206:207], v235 offset:59392
    v_exp_f32 v155, v155
    v_mfma_f32_16x16x32_bf16 v[238:241], v[246:249], v[128:131], v[238:241]
    v_cvt_pk_bf16_f32 v140, v152, v153
    v_cvt_pk_bf16_f32 v141, v154, v155
    v_mfma_f32_32x32x16_bf16 v[0:15], v[208:211], v[132:135], v[0:15]
    ds_read_b64_tr_b16 v[208:209], v232 offset:61440
    s_waitcnt lgkmcnt(13)
    ds_read_b64_tr_b16 v[210:211], v232 offset:63488
    v_exp_f32 v156, v156
    v_mfma_f32_32x32x16_bf16 v[16:31], v[212:215], v[132:135], v[16:31]
    ds_read_b64_tr_b16 v[212:213], v233 offset:61440
    s_waitcnt lgkmcnt(13)
    ds_read_b64_tr_b16 v[214:215], v233 offset:63488
    v_exp_f32 v157, v157
    v_mfma_f32_32x32x16_bf16 v[32:47], v[216:219], v[132:135], v[32:47]
    ds_read_b64_tr_b16 v[216:217], v234 offset:61440
    s_waitcnt lgkmcnt(13)
    ds_read_b64_tr_b16 v[218:219], v234 offset:63488
    v_exp_f32 v158, v158
    v_mfma_f32_32x32x16_bf16 v[48:63], v[220:223], v[132:135], v[48:63]
    ds_read_b64_tr_b16 v[220:221], v235 offset:61440
    s_waitcnt lgkmcnt(13)
    ds_read_b64_tr_b16 v[222:223], v235 offset:63488
    v_exp_f32 v159, v159
    v_mfma_f32_16x16x32_bf16 v[238:241], v[246:249], v[132:135], v[238:241]
    v_cvt_pk_bf16_f32 v142, v156, v157
    v_cvt_pk_bf16_f32 v143, v158, v159
    s_waitcnt vmcnt(6)
    s_barrier
    s_add_u32 m0, s24, 98304
    s_nop 0
    buffer_load_dwordx4 v237, s[8:11], s30 offen nt lds
    s_add_u32 m0, s24, 106496
    s_nop 0
    buffer_load_dwordx4 v237, s[8:11], s31 offen nt lds
    s_add_u32 m0, s24, 49152
    s_nop 0
    buffer_load_dwordx4 v236, s[4:7], s28 offen nt lds
    s_add_u32 m0, s24, 57344
    s_nop 0
    buffer_load_dwordx4 v236, s[4:7], s29 offen nt lds
    s_add_u32 s28, s28, 16384
    s_add_u32 s29, s29, 16384
    s_add_u32 s30, s30, 16384
    s_add_u32 s31, s31, 16384
    ds_read_b128 v[160:163], v224 offset:0
    s_waitcnt lgkmcnt(13)
    ds_read_b128 v[164:167], v225 offset:0
    ds_read_b128 v[168:171], v226 offset:0
    s_waitcnt lgkmcnt(13)
    ds_read_b128 v[172:175], v227 offset:0
    v_mfma_f32_32x32x16_bf16 v[0:15], v[192:195], v[136:139], v[0:15]
    v_max3_f32 v242, v96, v97, v98
    v_max3_f32 v244, v99, v100, v101
    v_mfma_f32_32x32x16_bf16 v[16:31], v[196:199], v[136:139], v[16:31]
    v_max3_f32 v242, v242, v102, v103
    v_max3_f32 v244, v244, v104, v105
    v_mfma_f32_32x32x16_bf16 v[32:47], v[200:203], v[136:139], v[32:47]
    v_max3_f32 v242, v242, v106, v107
    v_max3_f32 v244, v244, v108, v109
    s_waitcnt lgkmcnt(12)
    v_mfma_f32_32x32x16_bf16 v[48:63], v[204:207], v[136:139], v[48:63]
    v_max3_f32 v242, v242, v110, v111
    v_max3_f32 v244, v244, v112, v113
    v_mfma_f32_16x16x32_bf16 v[238:241], v[246:249], v[136:139], v[238:241]
    v_max3_f32 v242, v242, v114, v115
    v_max3_f32 v244, v244, v116, v117
    s_waitcnt lgkmcnt(10)
    v_mfma_f32_32x32x16_bf16 v[0:15], v[208:211], v[140:143], v[0:15]
    v_max3_f32 v242, v242, v118, v119
    v_max3_f32 v244, v244, v120, v121
    s_waitcnt lgkmcnt(8)
    v_mfma_f32_32x32x16_bf16 v[16:31], v[212:215], v[140:143], v[16:31]
    v_max3_f32 v242, v242, v122, v123
    v_max3_f32 v244, v244, v124, v125
    s_waitcnt lgkmcnt(6)
    v_mfma_f32_32x32x16_bf16 v[32:47], v[216:219], v[140:143], v[32:47]
    v_max3_f32 v242, v242, v126, v127
    v_max_f32 v242, v242, v244
    s_waitcnt lgkmcnt(4)
    v_mfma_f32_32x32x16_bf16 v[48:63], v[220:223], v[140:143], v[48:63]
    v_mov_b32 v243, v242
    s_nop 1
    v_permlane32_swap_b32 v242, v243
    v_mfma_f32_16x16x32_bf16 v[238:241], v[246:249], v[140:143], v[238:241]
    v_max_f32 v242, v242, v243
    v_cmp_lt_f32 vcc, s26, v242
    s_cbranch_vccnz L1_rare4
L1_back4:
    s_waitcnt lgkmcnt(3)
    v_mfma_f32_32x32x16_bf16 v[128:143], v[160:163], v[64:67], v[176:191]
    ds_read_b128 v[160:163], v228 offset:0
    v_exp_f32 v96, v96
    v_exp_f32 v97, v97
    s_waitcnt lgkmcnt(3)
    v_mfma_f32_32x32x16_bf16 v[128:143], v[164:167], v[68:71], v[128:143]
    ds_read_b128 v[164:167], v229 offset:0
    v_exp_f32 v98, v98
    v_exp_f32 v99, v99
    v_cvt_pk_bf16_f32 v96, v96, v97
    s_waitcnt lgkmcnt(3)
    v_mfma_f32_32x32x16_bf16 v[128:143], v[168:171], v[72:75], v[128:143]
    ds_read_b128 v[168:171], v230 offset:0
    v_cvt_pk_bf16_f32 v97, v98, v99
    v_exp_f32 v100, v100
    s_waitcnt lgkmcnt(3)
    v_mfma_f32_32x32x16_bf16 v[128:143], v[172:175], v[76:79], v[128:143]
    ds_read_b128 v[172:175], v231 offset:0
    v_exp_f32 v101, v101
    v_exp_f32 v102, v102
    v_exp_f32 v103, v103
    s_waitcnt lgkmcnt(3)
    v_mfma_f32_32x32x16_bf16 v[128:143], v[160:163], v[80:83], v[128:143]
    ds_read_b128 v[160:163], v224 offset:8192
    v_cvt_pk_bf16_f32 v98, v100, v101
    v_cvt_pk_bf16_f32 v99, v102, v103
    v_exp_f32 v104, v104
    s_waitcnt lgkmcnt(3)
    v_mfma_f32_32x32x16_bf16 v[128:143], v[164:167], v[84:87], v[128:143]
    ds_read_b128 v[164:167], v225 offset:8192
    v_exp_f32 v105, v105
    v_exp_f32 v106, v106
    s_waitcnt lgkmcnt(3)
    v_mfma_f32_32x32x16_bf16 v[128:143], v[168:171], v[88:91], v[128:143]
    ds_read_b128 v[168:171], v226 offset:8192
    v_exp_f32 v107, v107
    v_cvt_pk_bf16_f32 v100, v104, v105
    v_cvt_pk_bf16_f32 v101, v106, v107
    s_waitcnt lgkmcnt(3)
    v_mfma_f32_32x32x16_bf16 v[128:143], v[172:175], v[92:95], v[128:143]
    ds_read_b128 v[172:175], v227 offset:8192
    v_exp_f32 v108, v108
    v_exp_f32 v109, v109
    s_waitcnt lgkmcnt(3)
    v_mfma_f32_32x32x16_bf16 v[144:159], v[160:163], v[64:67], v[176:191]
    ds_read_b128 v[160:163], v228 offset:8192
    v_exp_f32 v110, v110
    v_exp_f32 v111, v111
    s_waitcnt lgkmcnt(3)
    v_mfma_f32_32x32x16_bf16 v[144:159], v[164:167], v[68:71], v[144:159]
    ds_read_b128 v[164:167], v229 offset:8192
    v_cvt_pk_bf16_f32 v102, v108, v109
    v_cvt_pk_bf16_f32 v103, v110, v111
    v_exp_f32 v112, v112
    ds_read_b64_tr_b16 v[192:193], v232 offset:0
    s_waitcnt lgkmcnt(4)
    v_mfma_f32_32x32x16_bf16 v[144:159], v[168:171], v[72:75], v[144:159]
    ds_read_b128 v[168:171], v230 offset:8192
    v_exp_f32 v113, v113
    ds_read_b64_tr_b16 v[194:195], v232 offset:2048
    v_exp_f32 v114, v114
    s_waitcnt lgkmcnt(5)
    v_mfma_f32_32x32x16_bf16 v[144:159], v[172:175], v[76:79], v[144:159]
    ds_read_b128 v[172:175], v231 offset:8192
    ds_read_b64_tr_b16 v[196:197], v233 offset:0
    v_exp_f32 v115, v115
    ds_read_b64_tr_b16 v[198:199], v233 offset:2048
    v_cvt_pk_bf16_f32 v104, v112, v113
    s_waitcnt lgkmcnt(7)
    v_mfma_f32_32x32x16_bf16 v[144:159], v[160:163], v[80:83], v[144:159]
    ds_read_b64_tr_b16 v[200:201], v234 offset:0
    v_cvt_pk_bf16_f32 v105, v114, v115
    ds_read_b64_tr_b16 v[202:203], v234 offset:2048
    v_exp_f32 v116, v116
    ds_read_b64_tr_b16 v[204:205], v235 offset:0
    s_waitcnt lgkmcnt(9)
    v_mfma_f32_32x32x16_bf16 v[144:159], v[164:167], v[84:87], v[144:159]
    v_exp_f32 v117, v117
    ds_read_b64_tr_b16 v[206:207], v235 offset:2048
    v_exp_f32 v118, v118
    s_waitcnt lgkmcnt(8)
    v_mfma_f32_32x32x16_bf16 v[144:159], v[168:171], v[88:91], v[144:159]
    ds_read_b64_tr_b16 v[208:209], v232 offset:4096
    v_exp_f32 v119, v119
    ds_read_b64_tr_b16 v[210:211], v232 offset:6144
    v_cvt_pk_bf16_f32 v106, v116, v117
    s_waitcnt lgkmcnt(8)
    v_mfma_f32_32x32x16_bf16 v[144:159], v[172:175], v[92:95], v[144:159]
    ds_read_b64_tr_b16 v[212:213], v233 offset:4096
    v_cvt_pk_bf16_f32 v107, v118, v119
    ds_read_b64_tr_b16 v[214:215], v233 offset:6144
    ds_read_b64_tr_b16 v[216:217], v234 offset:4096
    ds_read_b64_tr_b16 v[218:219], v234 offset:6144
    ds_read_b64_tr_b16 v[220:221], v235 offset:4096
    ds_read_b64_tr_b16 v[222:223], v235 offset:6144
    v_mfma_f32_32x32x16_bf16 v[0:15], v[192:195], v[96:99], v[0:15]
    ds_read_b64_tr_b16 v[192:193], v232 offset:8192
    s_waitcnt lgkmcnt(13)
    ds_read_b64_tr_b16 v[194:195], v232 offset:10240
    v_exp_f32 v120, v120
    v_mfma_f32_32x32x16_bf16 v[16:31], v[196:199], v[96:99], v[16:31]
    ds_read_b64_tr_b16 v[196:197], v233 offset:8192
    s_waitcnt lgkmcnt(13)
    ds_read_b64_tr_b16 v[198:199], v233 offset:10240
    v_exp_f32 v121, v121
    v_mfma_f32_32x32x16_bf16 v[32:47], v[200:203], v[96:99], v[32:47]
    ds_read_b64_tr_b16 v[200:201], v234 offset:8192
    s_waitcnt lgkmcnt(13)
    ds_read_b64_tr_b16 v[202:203], v234 offset:10240
    v_exp_f32 v122, v122
    v_mfma_f32_32x32x16_bf16 v[48:63], v[204:207], v[96:99], v[48:63]
    ds_read_b64_tr_b16 v[204:205], v235 offset:8192
    s_waitcnt lgkmcnt(13)
    ds_read_b64_tr_b16 v[206:207], v235 offset:10240
    v_exp_f32 v123, v123
    v_mfma_f32_16x16x32_bf16 v[238:241], v[246:249], v[96:99], v[238:241]
    v_cvt_pk_bf16_f32 v108, v120, v121
    v_cvt_pk_bf16_f32 v109, v122, v123
    v_mfma_f32_32x32x16_bf16 v[0:15], v[208:211], v[100:103], v[0:15]
    ds_read_b64_tr_b16 v[208:209], v232 offset:12288
    s_waitcnt lgkmcnt(13)
    ds_read_b64_tr_b16 v[210:211], v232 offset:14336
    v_exp_f32 v124, v124
    v_mfma_f32_32x32x16_bf16 v[16:31], v[212:215], v[100:103], v[16:31]
    ds_read_b64_tr_b16 v[212:213], v233 offset:12288
    s_waitcnt lgkmcnt(13)
    ds_read_b64_tr_b16 v[214:215], v233 offset:14336
    v_exp_f32 v125, v125
    v_mfma_f32_32x32x16_bf16 v[32:47], v[216:219], v[100:103], v[32:47]
    ds_read_b64_tr_b16 v[216:217], v234 offset:12288
    s_waitcnt lgkmcnt(13)
    ds_read_b64_tr_b16 v[218:219], v234 offset:14336
    v_exp_f32 v126, v126
    v_mfma_f32_32x32x16_bf16 v[48:63], v[220:223], v[100:103], v[48:63]
    ds_read_b64_tr_b16 v[220:221], v235 offset:12288
    s_waitcnt lgkmcnt(13)
    ds_read_b64_tr_b16 v[222:223], v235 offset:14336
    v_exp_f32 v127, v127
    v_mfma_f32_16x16x32_bf16 v[238:241], v[246:249], v[100:103], v[238:241]
    v_cvt_pk_bf16_f32 v110, v124, v125
    v_cvt_pk_bf16_f32 v111, v126, v127
    s_sub_u32 s27, s27, 1
    s_cmp_lg_u32 s27, 0
    s_cbranch_scc1 L1_loop
    s_waitcnt vmcnt(6)
    s_barrier
    s_add_u32 m0, s24, 114688
    s_nop 0
    buffer_load_dwordx4 v237, s[8:11], s30 offen nt lds
    s_add_u32 m0, s24, 122880
    s_nop 0
    buffer_load_dwordx4 v237, s[8:11], s31 offen nt lds
    s_add_u32 s28, s28, 16384
    s_add_u32 s29, s29, 16384
    s_add_u32 s30, s30, 16384
    s_add_u32 s31, s31, 16384
    ds_read_b128 v[160:163], v224 offset:16384
    s_waitcnt lgkmcnt(13)
    ds_read_b128 v[164:167], v225 offset:16384
    ds_read_b128 v[168:171], v226 offset:16384
    s_waitcnt lgkmcnt(13)
    ds_read_b128 v[172:175], v227 offset:16384
    v_mfma_f32_32x32x16_bf16 v[0:15], v[192:195], v[104:107], v[0:15]
    v_max3_f32 v242, v128, v129, v130
    v_max3_f32 v244, v131, v132, v133
    v_mfma_f32_32x32x16_bf16 v[16:31], v[196:199], v[104:107], v[16:31]
    v_max3_f32 v242, v242, v134, v135
    v_max3_f32 v244, v244, v136, v137
    v_mfma_f32_32x32x16_bf16 v[32:47], v[200:203], v[104:107], v[32:47]
    v_max3_f32 v242, v242, v138, v139
    v_max3_f32 v244, v244, v140, v141
    s_waitcnt lgkmcnt(12)
    v_mfma_f32_32x32x16_bf16 v[48:63], v[204:207], v[104:107], v[48:63]
    v_max3_f32 v242, v242, v142, v143
    v_max3_f32 v244, v244, v144, v145
    v_mfma_f32_16x16x32_bf16 v[238:241], v[246:249], v[104:107], v[238:241]
    v_max3_f32 v242, v242, v146, v147
    v_max3_f32 v244, v244, v148, v149
    s_waitcnt lgkmcnt(10)
    v_mfma_f32_32x32x16_bf16 v[0:15], v[208:211], v[108:111], v[0:15]
    v_max3_f32 v242, v242, v150, v151
    v_max3_f32 v244, v244, v152, v153
    s_waitcnt lgkmcnt(8)
    v_mfma_f32_32x32x16_bf16 v[16:31], v[212:215], v[108:111], v[16:31]
    v_max3_f32 v242, v242, v154, v155
    v_max3_f32 v244, v244, v156, v157
    s_waitcnt lgkmcnt(6)
    v_mfma_f32_32x32x16_bf16 v[32:47], v[216:219], v[108:111], v[32:47]
    v_max3_f32 v242, v242, v158, v159
    v_max_f32 v242, v242, v244
    s_waitcnt lgkmcnt(4)
    v_mfma_f32_32x32x16_bf16 v[48:63], v[220:223], v[108:111], v[48:63]
    v_mov_b32 v243, v242
    s_nop 1
    v_permlane32_swap_b32 v242, v243
    v_mfma_f32_16x16x32_bf16 v[238:241], v[246:249], v[108:111], v[238:241]
    v_max_f32 v242, v242, v243
    v_cmp_lt_f32 vcc, s26, v242
    s_cbranch_vccnz L1_rare5
L1_back5:
    s_waitcnt lgkmcnt(3)
    v_mfma_f32_32x32x16_bf16 v[96:111], v[160:163], v[64:67], v[176:191]
    ds_read_b128 v[160:163], v228 offset:16384
    v_exp_f32 v128, v128
    v_exp_f32 v129, v129
    s_waitcnt lgkmcnt(3)
    v_mfma_f32_32x32x16_bf16 v[96:111], v[164:167], v[68:71], v[96:111]
    ds_read_b128 v[164:167], v229 offset:16384
    v_exp_f32 v130, v130
    v_exp_f32 v131, v131
    v_cvt_pk_bf16_f32 v128, v128, v129
    s_waitcnt lgkmcnt(3)
    v_mfma_f32_32x32x16_bf16 v[96:111], v[168:171], v[72:75], v[96:111]
    ds_read_b128 v[168:171], v230 offset:16384
    v_cvt_pk_bf16_f32 v129, v130, v131
    v_exp_f32 v132, v132
    s_waitcnt lgkmcnt(3)
    v_mfma_f32_32x32x16_bf16 v[96:111], v[172:175], v[76:79], v[96:111]
    ds_read_b128 v[172:175], v231 offset:16384
    v_exp_f32 v133, v133
    v_exp_f32 v134, v134
    v_exp_f32 v135, v135
    s_waitcnt lgkmcnt(3)
    v_mfma_f32_32x32x16_bf16 v[96:111], v[160:163], v[80:83], v[96:111]
    ds_read_b128 v[160:163], v224 offset:24576
    v_cvt_pk_bf16_f32 v130, v132, v133
    v_cvt_pk_bf16_f32 v131, v134, v135
    v_exp_f32 v136, v136
    s_waitcnt lgkmcnt(3)
    v_mfma_f32_32x32x16_bf16 v[96:111], v[164:167], v[84:87], v[96:111]
    ds_read_b128 v[164:167], v225 offset:24576
    v_exp_f32 v137, v137
    v_exp_f32 v138, v138
    s_waitcnt lgkmcnt(3)
    v_mfma_f32_32x32x16_bf16 v[96:111], v[168:171], v[88:91], v[96:111]
    ds_read_b128 v[168:171], v226 offset:24576
    v_exp_f32 v139, v139
    v_cvt_pk_bf16_f32 v132, v136, v137
    v_cvt_pk_bf16_f32 v133, v138, v139
    s_waitcnt lgkmcnt(3)
    v_mfma_f32_32x32x16_bf16 v[96:111], v[172:175], v[92:95], v[96:111]
    ds_read_b128 v[172:175], v227 offset:24576
    v_exp_f32 v140, v140
    v_exp_f32 v141, v141
    s_waitcnt lgkmcnt(3)
    v_mfma_f32_32x32x16_bf16 v[112:127], v[160:163], v[64:67], v[176:191]
    ds_read_b128 v[160:163], v228 offset:24576
    v_exp_f32 v142, v142
    v_exp_f32 v143, v143
    s_waitcnt lgkmcnt(3)
    v_mfma_f32_32x32x16_bf16 v[112:127], v[164:167], v[68:71], v[112:127]
    ds_read_b128 v[164:167], v229 offset:24576
    v_cvt_pk_bf16_f32 v134, v140, v141
    v_cvt_pk_bf16_f32 v135, v142, v143
    v_exp_f32 v144, v144
    ds_read_b64_tr_b16 v[192:193], v232 offset:16384
    s_waitcnt lgkmcnt(4)
    v_mfma_f32_32x32x16_bf16 v[112:127], v[168:171], v[72:75], v[112:127]
    ds_read_b128 v[168:171], v230 offset:24576
    v_exp_f32 v145, v145
    ds_read_b64_tr_b16 v[194:195], v232 offset:18432
    v_exp_f32 v146, v146
    s_waitcnt lgkmcnt(5)
    v_mfma_f32_32x32x16_bf16 v[112:127], v[172:175], v[76:79], v[112:127]
    ds_read_b128 v[172:175], v231 offset:24576
    ds_read_b64_tr_b16 v[196:197], v233 offset:16384
    v_exp_f32 v147, v147
    ds_read_b64_tr_b16 v[198:199], v233 offset:18432
    v_cvt_pk_bf16_f32 v136, v144, v145
    s_waitcnt lgkmcnt(7)
    v_mfma_f32_32x32x16_bf16 v[112:127], v[160:163], v[80:83], v[112:127]
    ds_read_b64_tr_b16 v[200:201], v234 offset:16384
    v_cvt_pk_bf16_f32 v137, v146, v147
    ds_read_b64_tr_b16 v[202:203], v234 offset:18432
    v_exp_f32 v148, v148
    ds_read_b64_tr_b16 v[204:205], v235 offset:16384
    s_waitcnt lgkmcnt(9)
    v_mfma_f32_32x32x16_bf16 v[112:127], v[164:167], v[84:87], v[112:127]
    v_exp_f32 v149, v149
    ds_read_b64_tr_b16 v[206:207], v235 offset:18432
    v_exp_f32 v150, v150
    s_waitcnt lgkmcnt(8)
    v_mfma_f32_32x32x16_bf16 v[112:127], v[168:171], v[88:91], v[112:127]
    ds_read_b64_tr_b16 v[208:209], v232 offset:20480
    v_exp_f32 v151, v151
    ds_read_b64_tr_b16 v[210:211], v232 offset:22528
    v_cvt_pk_bf16_f32 v138, v148, v149
    s_waitcnt lgkmcnt(8)
    v_mfma_f32_32x32x16_bf16 v[112:127], v[172:175], v[92:95], v[112:127]
    ds_read_b64_tr_b16 v[212:213], v233 offset:20480
    v_cvt_pk_bf16_f32 v139, v150, v151
    ds_read_b64_tr_b16 v[214:215], v233 offset:22528
    ds_read_b64_tr_b16 v[216:217], v234 offset:20480
    ds_read_b64_tr_b16 v[218:219], v234 offset:22528
    ds_read_b64_tr_b16 v[220:221], v235 offset:20480
    ds_read_b64_tr_b16 v[222:223], v235 offset:22528
    v_mfma_f32_32x32x16_bf16 v[0:15], v[192:195], v[128:131], v[0:15]
    ds_read_b64_tr_b16 v[192:193], v232 offset:24576
    s_waitcnt lgkmcnt(13)
    ds_read_b64_tr_b16 v[194:195], v232 offset:26624
    v_exp_f32 v152, v152
    v_mfma_f32_32x32x16_bf16 v[16:31], v[196:199], v[128:131], v[16:31]
    ds_read_b64_tr_b16 v[196:197], v233 offset:24576
    s_waitcnt lgkmcnt(13)
    ds_read_b64_tr_b16 v[198:199], v233 offset:26624
    v_exp_f32 v153, v153
    v_mfma_f32_32x32x16_bf16 v[32:47], v[200:203], v[128:131], v[32:47]
    ds_read_b64_tr_b16 v[200:201], v234 offset:24576
    s_waitcnt lgkmcnt(13)
    ds_read_b64_tr_b16 v[202:203], v234 offset:26624
    v_exp_f32 v154, v154
    v_mfma_f32_32x32x16_bf16 v[48:63], v[204:207], v[128:131], v[48:63]
    ds_read_b64_tr_b16 v[204:205], v235 offset:24576
    s_waitcnt lgkmcnt(13)
    ds_read_b64_tr_b16 v[206:207], v235 offset:26624
    v_exp_f32 v155, v155
    v_mfma_f32_16x16x32_bf16 v[238:241], v[246:249], v[128:131], v[238:241]
    v_cvt_pk_bf16_f32 v140, v152, v153
    v_cvt_pk_bf16_f32 v141, v154, v155
    v_mfma_f32_32x32x16_bf16 v[0:15], v[208:211], v[132:135], v[0:15]
    ds_read_b64_tr_b16 v[208:209], v232 offset:28672
    s_waitcnt lgkmcnt(13)
    ds_read_b64_tr_b16 v[210:211], v232 offset:30720
    v_exp_f32 v156, v156
    v_mfma_f32_32x32x16_bf16 v[16:31], v[212:215], v[132:135], v[16:31]
    ds_read_b64_tr_b16 v[212:213], v233 offset:28672
    s_waitcnt lgkmcnt(13)
    ds_read_b64_tr_b16 v[214:215], v233 offset:30720
    v_exp_f32 v157, v157
    v_mfma_f32_32x32x16_bf16 v[32:47], v[216:219], v[132:135], v[32:47]
    ds_read_b64_tr_b16 v[216:217], v234 offset:28672
    s_waitcnt lgkmcnt(13)
    ds_read_b64_tr_b16 v[218:219], v234 offset:30720
    v_exp_f32 v158, v158
    v_mfma_f32_32x32x16_bf16 v[48:63], v[220:223], v[132:135], v[48:63]
    ds_read_b64_tr_b16 v[220:221], v235 offset:28672
    s_waitcnt lgkmcnt(13)
    ds_read_b64_tr_b16 v[222:223], v235 offset:30720
    v_exp_f32 v159, v159
    v_mfma_f32_16x16x32_bf16 v[238:241], v[246:249], v[132:135], v[238:241]
    v_cvt_pk_bf16_f32 v142, v156, v157
    v_cvt_pk_bf16_f32 v143, v158, v159
    s_waitcnt vmcnt(4)
    s_barrier
    ds_read_b128 v[160:163], v224 offset:32768
    s_waitcnt lgkmcnt(13)
    ds_read_b128 v[164:167], v225 offset:32768
    ds_read_b128 v[168:171], v226 offset:32768
    s_waitcnt lgkmcnt(13)
    ds_read_b128 v[172:175], v227 offset:32768
    v_mfma_f32_32x32x16_bf16 v[0:15], v[192:195], v[136:139], v[0:15]
    v_max3_f32 v242, v96, v97, v98
    v_max3_f32 v244, v99, v100, v101
    v_mfma_f32_32x32x16_bf16 v[16:31], v[196:199], v[136:139], v[16:31]
    v_max3_f32 v242, v242, v102, v103
    v_max3_f32 v244, v244, v104, v105
    v_mfma_f32_32x32x16_bf16 v[32:47], v[200:203], v[136:139], v[32:47]
    v_max3_f32 v242, v242, v106, v107
    v_max3_f32 v244, v244, v108, v109
    s_waitcnt lgkmcnt(12)
    v_mfma_f32_32x32x16_bf16 v[48:63], v[204:207], v[136:139], v[48:63]
    v_max3_f32 v242, v242, v110, v111
    v_max3_f32 v244, v244, v112, v113
    v_mfma_f32_16x16x32_bf16 v[238:241], v[246:249], v[136:139], v[238:241]
    v_max3_f32 v242, v242, v114, v115
    v_max3_f32 v244, v244, v116, v117
    s_waitcnt lgkmcnt(10)
    v_mfma_f32_32x32x16_bf16 v[0:15], v[208:211], v[140:143], v[0:15]
    v_max3_f32 v242, v242, v118, v119
    v_max3_f32 v244, v244, v120, v121
    s_waitcnt lgkmcnt(8)
    v_mfma_f32_32x32x16_bf16 v[16:31], v[212:215], v[140:143], v[16:31]
    v_max3_f32 v242, v242, v122, v123
    v_max3_f32 v244, v244, v124, v125
    s_waitcnt lgkmcnt(6)
    v_mfma_f32_32x32x16_bf16 v[32:47], v[216:219], v[140:143], v[32:47]
    v_max3_f32 v242, v242, v126, v127
    v_max_f32 v242, v242, v244
    s_waitcnt lgkmcnt(4)
    v_mfma_f32_32x32x16_bf16 v[48:63], v[220:223], v[140:143], v[48:63]
    v_mov_b32 v243, v242
    s_nop 1
    v_permlane32_swap_b32 v242, v243
    v_mfma_f32_16x16x32_bf16 v[238:241], v[246:249], v[140:143], v[238:241]
    v_max_f32 v242, v242, v243
    v_cmp_lt_f32 vcc, s26, v242
    s_cbranch_vccnz L1_rare6
L1_back6:
    s_waitcnt lgkmcnt(3)
    v_mfma_f32_32x32x16_bf16 v[128:143], v[160:163], v[64:67], v[176:191]
    ds_read_b128 v[160:163], v228 offset:32768
    v_exp_f32 v96, v96
    v_exp_f32 v97, v97
    s_waitcnt lgkmcnt(3)
    v_mfma_f32_32x32x16_bf16 v[128:143], v[164:167], v[68:71], v[128:143]
    ds_read_b128 v[164:167], v229 offset:32768
    v_exp_f32 v98, v98
    v_exp_f32 v99, v99
    v_cvt_pk_bf16_f32 v96, v96, v97
    s_waitcnt lgkmcnt(3)
    v_mfma_f32_32x32x16_bf16 v[128:143], v[168:171], v[72:75], v[128:143]
    ds_read_b128 v[168:171], v230 offset:32768
    v_cvt_pk_bf16_f32 v97, v98, v99
    v_exp_f32 v100, v100
    s_waitcnt lgkmcnt(3)
    v_mfma_f32_32x32x16_bf16 v[128:143], v[172:175], v[76:79], v[128:143]
    ds_read_b128 v[172:175], v231 offset:32768
    v_exp_f32 v101, v101
    v_exp_f32 v102, v102
    v_exp_f32 v103, v103
    s_waitcnt lgkmcnt(3)
    v_mfma_f32_32x32x16_bf16 v[128:143], v[160:163], v[80:83], v[128:143]
    ds_read_b128 v[160:163], v224 offset:40960
    v_cvt_pk_bf16_f32 v98, v100, v101
    v_cvt_pk_bf16_f32 v99, v102, v103
    v_exp_f32 v104, v104
    s_waitcnt lgkmcnt(3)
    v_mfma_f32_32x32x16_bf16 v[128:143], v[164:167], v[84:87], v[128:143]
    ds_read_b128 v[164:167], v225 offset:40960
    v_exp_f32 v105, v105
    v_exp_f32 v106, v106
    s_waitcnt lgkmcnt(3)
    v_mfma_f32_32x32x16_bf16 v[128:143], v[168:171], v[88:91], v[128:143]
    ds_read_b128 v[168:171], v226 offset:40960
    v_exp_f32 v107, v107
    v_cvt_pk_bf16_f32 v100, v104, v105
    v_cvt_pk_bf16_f32 v101, v106, v107
    s_waitcnt lgkmcnt(3)
    v_mfma_f32_32x32x16_bf16 v[128:143], v[172:175], v[92:95], v[128:143]
    ds_read_b128 v[172:175], v227 offset:40960
    v_exp_f32 v108, v108
    v_exp_f32 v109, v109
    s_waitcnt lgkmcnt(3)
    v_mfma_f32_32x32x16_bf16 v[144:159], v[160:163], v[64:67], v[176:191]
    ds_read_b128 v[160:163], v228 offset:40960
    v_exp_f32 v110, v110
    v_exp_f32 v111, v111
    s_waitcnt lgkmcnt(3)
    v_mfma_f32_32x32x16_bf16 v[144:159], v[164:167], v[68:71], v[144:159]
    ds_read_b128 v[164:167], v229 offset:40960
    v_cvt_pk_bf16_f32 v102, v108, v109
    v_cvt_pk_bf16_f32 v103, v110, v111
    v_exp_f32 v112, v112
    ds_read_b64_tr_b16 v[192:193], v232 offset:32768
    s_waitcnt lgkmcnt(4)
    v_mfma_f32_32x32x16_bf16 v[144:159], v[168:171], v[72:75], v[144:159]
    ds_read_b128 v[168:171], v230 offset:40960
    v_exp_f32 v113, v113
    ds_read_b64_tr_b16 v[194:195], v232 offset:34816
    v_exp_f32 v114, v114
    s_waitcnt lgkmcnt(5)
    v_mfma_f32_32x32x16_bf16 v[144:159], v[172:175], v[76:79], v[144:159]
    ds_read_b128 v[172:175], v231 offset:40960
    ds_read_b64_tr_b16 v[196:197], v233 offset:32768
    v_exp_f32 v115, v115
    ds_read_b64_tr_b16 v[198:199], v233 offset:34816
    v_cvt_pk_bf16_f32 v104, v112, v113
    s_waitcnt lgkmcnt(7)
    v_mfma_f32_32x32x16_bf16 v[144:159], v[160:163], v[80:83], v[144:159]
    ds_read_b64_tr_b16 v[200:201], v234 offset:32768
    v_cvt_pk_bf16_f32 v105, v114, v115
    ds_read_b64_tr_b16 v[202:203], v234 offset:34816
    v_exp_f32 v116, v116
    ds_read_b64_tr_b16 v[204:205], v235 offset:32768
    s_waitcnt lgkmcnt(9)
    v_mfma_f32_32x32x16_bf16 v[144:159], v[164:167], v[84:87], v[144:159]
    v_exp_f32 v117, v117
    ds_read_b64_tr_b16 v[206:207], v235 offset:34816
    v_exp_f32 v118, v118
    s_waitcnt lgkmcnt(8)
    v_mfma_f32_32x32x16_bf16 v[144:159], v[168:171], v[88:91], v[144:159]
    ds_read_b64_tr_b16 v[208:209], v232 offset:36864
    v_exp_f32 v119, v119
    ds_read_b64_tr_b16 v[210:211], v232 offset:38912
    v_cvt_pk_bf16_f32 v106, v116, v117
    s_waitcnt lgkmcnt(8)
    v_mfma_f32_32x32x16_bf16 v[144:159], v[172:175], v[92:95], v[144:159]
    ds_read_b64_tr_b16 v[212:213], v233 offset:36864
    v_cvt_pk_bf16_f32 v107, v118, v119
    ds_read_b64_tr_b16 v[214:215], v233 offset:38912
    ds_read_b64_tr_b16 v[216:217], v234 offset:36864
    ds_read_b64_tr_b16 v[218:219], v234 offset:38912
    ds_read_b64_tr_b16 v[220:221], v235 offset:36864
    ds_read_b64_tr_b16 v[222:223], v235 offset:38912
    v_mfma_f32_32x32x16_bf16 v[0:15], v[192:195], v[96:99], v[0:15]
    ds_read_b64_tr_b16 v[192:193], v232 offset:40960
    s_waitcnt lgkmcnt(13)
    ds_read_b64_tr_b16 v[194:195], v232 offset:43008
    v_exp_f32 v120, v120
    v_mfma_f32_32x32x16_bf16 v[16:31], v[196:199], v[96:99], v[16:31]
    ds_read_b64_tr_b16 v[196:197], v233 offset:40960
    s_waitcnt lgkmcnt(13)
    ds_read_b64_tr_b16 v[198:199], v233 offset:43008
    v_exp_f32 v121, v121
    v_mfma_f32_32x32x16_bf16 v[32:47], v[200:203], v[96:99], v[32:47]
    ds_read_b64_tr_b16 v[200:201], v234 offset:40960
    s_waitcnt lgkmcnt(13)
    ds_read_b64_tr_b16 v[202:203], v234 offset:43008
    v_exp_f32 v122, v122
    v_mfma_f32_32x32x16_bf16 v[48:63], v[204:207], v[96:99], v[48:63]
    ds_read_b64_tr_b16 v[204:205], v235 offset:40960
    s_waitcnt lgkmcnt(13)
    ds_read_b64_tr_b16 v[206:207], v235 offset:43008
    v_exp_f32 v123, v123
    v_mfma_f32_16x16x32_bf16 v[238:241], v[246:249], v[96:99], v[238:241]
    v_cvt_pk_bf16_f32 v108, v120, v121
    v_cvt_pk_bf16_f32 v109, v122, v123
    v_mfma_f32_32x32x16_bf16 v[0:15], v[208:211], v[100:103], v[0:15]
    ds_read_b64_tr_b16 v[208:209], v232 offset:45056
    s_waitcnt lgkmcnt(13)
    ds_read_b64_tr_b16 v[210:211], v232 offset:47104
    v_exp_f32 v124, v124
    v_mfma_f32_32x32x16_bf16 v[16:31], v[212:215], v[100:103], v[16:31]
    ds_read_b64_tr_b16 v[212:213], v233 offset:45056
    s_waitcnt lgkmcnt(13)
    ds_read_b64_tr_b16 v[214:215], v233 offset:47104
    v_exp_f32 v125, v125
    v_mfma_f32_32x32x16_bf16 v[32:47], v[216:219], v[100:103], v[32:47]
    ds_read_b64_tr_b16 v[216:217], v234 offset:45056
    s_waitcnt lgkmcnt(13)
    ds_read_b64_tr_b16 v[218:219], v234 offset:47104
    v_exp_f32 v126, v126
    v_mfma_f32_32x32x16_bf16 v[48:63], v[220:223], v[100:103], v[48:63]
    ds_read_b64_tr_b16 v[220:221], v235 offset:45056
    s_waitcnt lgkmcnt(13)
    ds_read_b64_tr_b16 v[222:223], v235 offset:47104
    v_exp_f32 v127, v127
    v_mfma_f32_16x16x32_bf16 v[238:241], v[246:249], v[100:103], v[238:241]
    v_cvt_pk_bf16_f32 v110, v124, v125
    v_cvt_pk_bf16_f32 v111, v126, v127
    s_waitcnt vmcnt(0)
    s_barrier
    v_mfma_f32_32x32x16_bf16 v[0:15], v[192:195], v[104:107], v[0:15]
    v_max3_f32 v242, v128, v129, v130
    v_max3_f32 v244, v131, v132, v133
    s_waitcnt lgkmcnt(12)
    v_mfma_f32_32x32x16_bf16 v[16:31], v[196:199], v[104:107], v[16:31]
    v_max3_f32 v242, v242, v134, v135
    v_max3_f32 v244, v244, v136, v137
    s_waitcnt lgkmcnt(10)
    v_mfma_f32_32x32x16_bf16 v[32:47], v[200:203], v[104:107], v[32:47]
    v_max3_f32 v242, v242, v138, v139
    v_max3_f32 v244, v244, v140, v141
    s_waitcnt lgkmcnt(8)
    v_mfma_f32_32x32x16_bf16 v[48:63], v[204:207], v[104:107], v[48:63]
    v_max3_f32 v242, v242, v142, v143
    v_max3_f32 v244, v244, v144, v145
    v_mfma_f32_16x16x32_bf16 v[238:241], v[246:249], v[104:107], v[238:241]
    v_max3_f32 v242, v242, v146, v147
    v_max3_f32 v244, v244, v148, v149
    s_waitcnt lgkmcnt(6)
    v_mfma_f32_32x32x16_bf16 v[0:15], v[208:211], v[108:111], v[0:15]
    v_max3_f32 v242, v242, v150, v151
    v_max3_f32 v244, v244, v152, v153
    s_waitcnt lgkmcnt(4)
    v_mfma_f32_32x32x16_bf16 v[16:31], v[212:215], v[108:111], v[16:31]
    v_max3_f32 v242, v242, v154, v155
    v_max3_f32 v244, v244, v156, v157
    s_waitcnt lgkmcnt(2)
    v_mfma_f32_32x32x16_bf16 v[32:47], v[216:219], v[108:111], v[32:47]
    v_max3_f32 v242, v242, v158, v159
    v_max_f32 v242, v242, v244
    s_waitcnt lgkmcnt(0)
    v_mfma_f32_32x32x16_bf16 v[48:63], v[220:223], v[108:111], v[48:63]
    v_mov_b32 v243, v242
    s_nop 1
    v_permlane32_swap_b32 v242, v243
    v_mfma_f32_16x16x32_bf16 v[238:241], v[246:249], v[108:111], v[238:241]
    v_max_f32 v242, v242, v243
    v_cmp_lt_f32 vcc, s26, v242
    s_cbranch_vccnz L1_rare7
L1_back7:
    ds_read_b64_tr_b16 v[192:193], v232 offset:49152
    ds_read_b64_tr_b16 v[194:195], v232 offset:51200
    ds_read_b64_tr_b16 v[196:197], v233 offset:49152
    ds_read_b64_tr_b16 v[198:199], v233 offset:51200
    ds_read_b64_tr_b16 v[200:201], v234 offset:49152
    ds_read_b64_tr_b16 v[202:203], v234 offset:51200
    ds_read_b64_tr_b16 v[204:205], v235 offset:49152
    ds_read_b64_tr_b16 v[206:207], v235 offset:51200
    ds_read_b64_tr_b16 v[208:209], v232 offset:53248
    ds_read_b64_tr_b16 v[210:211], v232 offset:55296
    ds_read_b64_tr_b16 v[212:213], v233 offset:53248
    ds_read_b64_tr_b16 v[214:215], v233 offset:55296
    ds_read_b64_tr_b16 v[216:217], v234 offset:53248
    ds_read_b64_tr_b16 v[218:219], v234 offset:55296
    ds_read_b64_tr_b16 v[220:221], v235 offset:53248
    s_waitcnt lgkmcnt(13)
    ds_read_b64_tr_b16 v[222:223], v235 offset:55296
    v_exp_f32 v128, v128
    v_exp_f32 v129, v129
    v_exp_f32 v130, v130
    v_exp_f32 v131, v131
    v_cvt_pk_bf16_f32 v128, v128, v129
    v_cvt_pk_bf16_f32 v129, v130, v131
    v_exp_f32 v132, v132
    v_exp_f32 v133, v133
    v_exp_f32 v134, v134
    v_exp_f32 v135, v135
    v_cvt_pk_bf16_f32 v130, v132, v133
    v_cvt_pk_bf16_f32 v131, v134, v135
    v_exp_f32 v136, v136
    v_exp_f32 v137, v137
    v_exp_f32 v138, v138
    v_exp_f32 v139, v139
    v_cvt_pk_bf16_f32 v132, v136, v137
    v_cvt_pk_bf16_f32 v133, v138, v139
    v_exp_f32 v140, v140
    v_exp_f32 v141, v141
    v_exp_f32 v142, v142
    v_exp_f32 v143, v143
    v_cvt_pk_bf16_f32 v134, v140, v141
    v_cvt_pk_bf16_f32 v135, v142, v143
    v_mfma_f32_32x32x16_bf16 v[0:15], v[192:195], v[128:131], v[0:15]
    ds_read_b64_tr_b16 v[192:193], v232 offset:57344
    s_waitcnt lgkmcnt(13)
    ds_read_b64_tr_b16 v[194:195], v232 offset:59392
    v_exp_f32 v144, v144
    v_exp_f32 v145, v145
    v_mfma_f32_32x32x16_bf16 v[16:31], v[196:199], v[128:131], v[16:31]
    ds_read_b64_tr_b16 v[196:197], v233 offset:57344
    s_waitcnt lgkmcnt(13)
    ds_read_b64_tr_b16 v[198:199], v233 offset:59392
    v_exp_f32 v146, v146
    v_exp_f32 v147, v147
    v_mfma_f32_32x32x16_bf16 v[32:47], v[200:203], v[128:131], v[32:47]
    ds_read_b64_tr_b16 v[200:201], v234 offset:57344
    s_waitcnt lgkmcnt(13)
    ds_read_b64_tr_b16 v[202:203], v234 offset:59392
    v_cvt_pk_bf16_f32 v136, v144, v145
    v_cvt_pk_bf16_f32 v137, v146, v147
    v_exp_f32 v148, v148
    v_mfma_f32_32x32x16_bf16 v[48:63], v[204:207], v[128:131], v[48:63]
    ds_read_b64_tr_b16 v[204:205], v235 offset:57344
    s_waitcnt lgkmcnt(13)
    ds_read_b64_tr_b16 v[206:207], v235 offset:59392
    v_exp_f32 v149, v149
    v_exp_f32 v150, v150
    v_mfma_f32_16x16x32_bf16 v[238:241], v[246:249], v[128:131], v[238:241]
    v_exp_f32 v151, v151
    v_cvt_pk_bf16_f32 v138, v148, v149
    v_cvt_pk_bf16_f32 v139, v150, v151
    v_mfma_f32_32x32x16_bf16 v[0:15], v[208:211], v[132:135], v[0:15]
    ds_read_b64_tr_b16 v[208:209], v232 offset:61440
    s_waitcnt lgkmcnt(13)
    ds_read_b64_tr_b16 v[210:211], v232 offset:63488
    v_exp_f32 v152, v152
    v_exp_f32 v153, v153
    v_mfma_f32_32x32x16_bf16 v[16:31], v[212:215], v[132:135], v[16:31]
    ds_read_b64_tr_b16 v[212:213], v233 offset:61440
    s_waitcnt lgkmcnt(13)
    ds_read_b64_tr_b16 v[214:215], v233 offset:63488
    v_exp_f32 v154, v154
    v_exp_f32 v155, v155
    v_mfma_f32_32x32x16_bf16 v[32:47], v[216:219], v[132:135], v[32:47]
    ds_read_b64_tr_b16 v[216:217], v234 offset:61440
    s_waitcnt lgkmcnt(13)
    ds_read_b64_tr_b16 v[218:219], v234 offset:63488
    v_cvt_pk_bf16_f32 v140, v152, v153
    v_cvt_pk_bf16_f32 v141, v154, v155
    v_exp_f32 v156, v156
    v_mfma_f32_32x32x16_bf16 v[48:63], v[220:223], v[132:135], v[48:63]
    ds_read_b64_tr_b16 v[220:221], v235 offset:61440
    s_waitcnt lgkmcnt(13)
    ds_read_b64_tr_b16 v[222:223], v235 offset:63488
    v_exp_f32 v157, v157
    v_exp_f32 v158, v158
    v_mfma_f32_16x16x32_bf16 v[238:241], v[246:249], v[132:135], v[238:241]
    v_exp_f32 v159, v159
    v_cvt_pk_bf16_f32 v142, v156, v157
    v_cvt_pk_bf16_f32 v143, v158, v159
    v_mfma_f32_32x32x16_bf16 v[0:15], v[192:195], v[136:139], v[0:15]
    s_waitcnt lgkmcnt(12)
    v_mfma_f32_32x32x16_bf16 v[16:31], v[196:199], v[136:139], v[16:31]
    s_waitcnt lgkmcnt(10)
    v_mfma_f32_32x32x16_bf16 v[32:47], v[200:203], v[136:139], v[32:47]
    s_waitcnt lgkmcnt(8)
    v_mfma_f32_32x32x16_bf16 v[48:63], v[204:207], v[136:139], v[48:63]
    v_mfma_f32_16x16x32_bf16 v[238:241], v[246:249], v[136:139], v[238:241]
    s_waitcnt lgkmcnt(6)
    v_mfma_f32_32x32x16_bf16 v[0:15], v[208:211], v[140:143], v[0:15]
    s_waitcnt lgkmcnt(4)
    v_mfma_f32_32x32x16_bf16 v[16:31], v[212:215], v[140:143], v[16:31]
    s_waitcnt lgkmcnt(2)
    v_mfma_f32_32x32x16_bf16 v[32:47], v[216:219], v[140:143], v[32:47]
    s_waitcnt lgkmcnt(0)
    v_mfma_f32_32x32x16_bf16 v[48:63], v[220:223], v[140:143], v[48:63]
    v_mfma_f32_16x16x32_bf16 v[238:241], v[246:249], v[140:143], v[238:241]
    s_nop 7
    v_permlane16_swap_b32 v238, v239
    v_mov_b32 v243, v238
    s_nop 1
    v_permlane32_swap_b32 v238, v243
    v_rcp_f32 v240, v238
    v_lshlrev_b32 v252, 4, v252
    s_mov_b32 s32, 4096
    v_mul_f32 v0, v0, v240
    v_mul_f32 v1, v1, v240
    v_mul_f32 v2, v2, v240
    v_mul_f32 v3, v3, v240
    v_mul_f32 v4, v4, v240
    v_mul_f32 v5, v5, v240
    v_mul_f32 v6, v6, v240
    v_mul_f32 v7, v7, v240
    v_cvt_pk_bf16_f32 v96, v0, v1
    v_cvt_pk_bf16_f32 v97, v2, v3
    v_cvt_pk_bf16_f32 v98, v4, v5
    v_cvt_pk_bf16_f32 v99, v6, v7
    s_nop 0
    v_permlane32_swap_b32 v96, v98
    v_permlane32_swap_b32 v97, v99
    buffer_store_dwordx4 v[96:99], v252, s[20:23], 0 offen
    v_mul_f32 v8, v8, v240
    v_mul_f32 v9, v9, v240
    v_mul_f32 v10, v10, v240
    v_mul_f32 v11, v11, v240
    v_mul_f32 v12, v12, v240
    v_mul_f32 v13, v13, v240
    v_mul_f32 v14, v14, v240
    v_mul_f32 v15, v15, v240
    v_cvt_pk_bf16_f32 v100, v8, v9
    v_cvt_pk_bf16_f32 v101, v10, v11
    v_cvt_pk_bf16_f32 v102, v12, v13
    v_cvt_pk_bf16_f32 v103, v14, v15
    s_nop 0
    v_permlane32_swap_b32 v100, v102
    v_permlane32_swap_b32 v101, v103
    buffer_store_dwordx4 v[100:103], v252, s[20:23], 0 offen offset:1024
    v_mul_f32 v16, v16, v240
    v_mul_f32 v17, v17, v240
    v_mul_f32 v18, v18, v240
    v_mul_f32 v19, v19, v240
    v_mul_f32 v20, v20, v240
    v_mul_f32 v21, v21, v240
    v_mul_f32 v22, v22, v240
    v_mul_f32 v23, v23, v240
    v_cvt_pk_bf16_f32 v104, v16, v17
    v_cvt_pk_bf16_f32 v105, v18, v19
    v_cvt_pk_bf16_f32 v106, v20, v21
    v_cvt_pk_bf16_f32 v107, v22, v23
    s_nop 0
    v_permlane32_swap_b32 v104, v106
    v_permlane32_swap_b32 v105, v107
    buffer_store_dwordx4 v[104:107], v252, s[20:23], 0 offen offset:2048
    v_mul_f32 v24, v24, v240
    v_mul_f32 v25, v25, v240
    v_mul_f32 v26, v26, v240
    v_mul_f32 v27, v27, v240
    v_mul_f32 v28, v28, v240
    v_mul_f32 v29, v29, v240
    v_mul_f32 v30, v30, v240
    v_mul_f32 v31, v31, v240
    v_cvt_pk_bf16_f32 v108, v24, v25
    v_cvt_pk_bf16_f32 v109, v26, v27
    v_cvt_pk_bf16_f32 v110, v28, v29
    v_cvt_pk_bf16_f32 v111, v30, v31
    s_nop 0
    v_permlane32_swap_b32 v108, v110
    v_permlane32_swap_b32 v109, v111
    buffer_store_dwordx4 v[108:111], v252, s[20:23], 0 offen offset:3072
    v_mul_f32 v32, v32, v240
    v_mul_f32 v33, v33, v240
    v_mul_f32 v34, v34, v240
    v_mul_f32 v35, v35, v240
    v_mul_f32 v36, v36, v240
    v_mul_f32 v37, v37, v240
    v_mul_f32 v38, v38, v240
    v_mul_f32 v39, v39, v240
    v_cvt_pk_bf16_f32 v112, v32, v33
    v_cvt_pk_bf16_f32 v113, v34, v35
    v_cvt_pk_bf16_f32 v114, v36, v37
    v_cvt_pk_bf16_f32 v115, v38, v39
    s_nop 0
    v_permlane32_swap_b32 v112, v114
    v_permlane32_swap_b32 v113, v115
    buffer_store_dwordx4 v[112:115], v252, s[20:23], s32 offen
    v_mul_f32 v40, v40, v240
    v_mul_f32 v41, v41, v240
    v_mul_f32 v42, v42, v240
    v_mul_f32 v43, v43, v240
    v_mul_f32 v44, v44, v240
    v_mul_f32 v45, v45, v240
    v_mul_f32 v46, v46, v240
    v_mul_f32 v47, v47, v240
    v_cvt_pk_bf16_f32 v116, v40, v41
    v_cvt_pk_bf16_f32 v117, v42, v43
    v_cvt_pk_bf16_f32 v118, v44, v45
    v_cvt_pk_bf16_f32 v119, v46, v47
    s_nop 0
    v_permlane32_swap_b32 v116, v118
    v_permlane32_swap_b32 v117, v119
    buffer_store_dwordx4 v[116:119], v252, s[20:23], s32 offen offset:1024
    v_mul_f32 v48, v48, v240
    v_mul_f32 v49, v49, v240
    v_mul_f32 v50, v50, v240
    v_mul_f32 v51, v51, v240
    v_mul_f32 v52, v52, v240
    v_mul_f32 v53, v53, v240
    v_mul_f32 v54, v54, v240
    v_mul_f32 v55, v55, v240
    v_cvt_pk_bf16_f32 v120, v48, v49
    v_cvt_pk_bf16_f32 v121, v50, v51
    v_cvt_pk_bf16_f32 v122, v52, v53
    v_cvt_pk_bf16_f32 v123, v54, v55
    s_nop 0
    v_permlane32_swap_b32 v120, v122
    v_permlane32_swap_b32 v121, v123
    buffer_store_dwordx4 v[120:123], v252, s[20:23], s32 offen offset:2048
    v_mul_f32 v56, v56, v240
    v_mul_f32 v57, v57, v240
    v_mul_f32 v58, v58, v240
    v_mul_f32 v59, v59, v240
    v_mul_f32 v60, v60, v240
    v_mul_f32 v61, v61, v240
    v_mul_f32 v62, v62, v240
    v_mul_f32 v63, v63, v240
    v_cvt_pk_bf16_f32 v124, v56, v57
    v_cvt_pk_bf16_f32 v125, v58, v59
    v_cvt_pk_bf16_f32 v126, v60, v61
    v_cvt_pk_bf16_f32 v127, v62, v63
    s_nop 0
    v_permlane32_swap_b32 v124, v126
    v_permlane32_swap_b32 v125, v127
    buffer_store_dwordx4 v[124:127], v252, s[20:23], s32 offen offset:3072
L1_exit:
    s_endpgm
L1_rare1:
    s_nop 15
    v_max_f32 v244, 0, v242
    v_exp_f32 v243, -v244
    v_sub_f32 v128, v128, v244
    v_sub_f32 v129, v129, v244
    v_sub_f32 v130, v130, v244
    v_sub_f32 v131, v131, v244
    v_sub_f32 v132, v132, v244
    v_sub_f32 v133, v133, v244
    v_sub_f32 v134, v134, v244
    v_sub_f32 v135, v135, v244
    v_sub_f32 v136, v136, v244
    v_sub_f32 v137, v137, v244
    v_sub_f32 v138, v138, v244
    v_sub_f32 v139, v139, v244
    v_sub_f32 v140, v140, v244
    v_sub_f32 v141, v141, v244
    v_sub_f32 v142, v142, v244
    v_sub_f32 v143, v143, v244
    v_sub_f32 v144, v144, v244
    v_sub_f32 v145, v145, v244
    v_sub_f32 v146, v146, v244
    v_sub_f32 v147, v147, v244
    v_sub_f32 v148, v148, v244
    v_sub_f32 v149, v149, v244
    v_sub_f32 v150, v150, v244
    v_sub_f32 v151, v151, v244
    v_sub_f32 v152, v152, v244
    v_sub_f32 v153, v153, v244
    v_sub_f32 v154, v154, v244
    v_sub_f32 v155, v155, v244
    v_sub_f32 v156, v156, v244
    v_sub_f32 v157, v157, v244
    v_sub_f32 v158, v158, v244
    v_sub_f32 v159, v159, v244
    v_sub_f32 v176, v176, v244
    v_sub_f32 v177, v177, v244
    v_sub_f32 v178, v178, v244
    v_sub_f32 v179, v179, v244
    v_sub_f32 v180, v180, v244
    v_sub_f32 v181, v181, v244
    v_sub_f32 v182, v182, v244
    v_sub_f32 v183, v183, v244
    v_sub_f32 v184, v184, v244
    v_sub_f32 v185, v185, v244
    v_sub_f32 v186, v186, v244
    v_sub_f32 v187, v187, v244
    v_sub_f32 v188, v188, v244
    v_sub_f32 v189, v189, v244
    v_sub_f32 v190, v190, v244
    v_sub_f32 v191, v191, v244
    v_mul_f32 v0, v0, v243
    v_mul_f32 v1, v1, v243
    v_mul_f32 v2, v2, v243
    v_mul_f32 v3, v3, v243
    v_mul_f32 v4, v4, v243
    v_mul_f32 v5, v5, v243
    v_mul_f32 v6, v6, v243
    v_mul_f32 v7, v7, v243
    v_mul_f32 v8, v8, v243
    v_mul_f32 v9, v9, v243
    v_mul_f32 v10, v10, v243
    v_mul_f32 v11, v11, v243
    v_mul_f32 v12, v12, v243
    v_mul_f32 v13, v13, v243
    v_mul_f32 v14, v14, v243
    v_mul_f32 v15, v15, v243
    v_mul_f32 v16, v16, v243
    v_mul_f32 v17, v17, v243
    v_mul_f32 v18, v18, v243
    v_mul_f32 v19, v19, v243
    v_mul_f32 v20, v20, v243
    v_mul_f32 v21, v21, v243
    v_mul_f32 v22, v22, v243
    v_mul_f32 v23, v23, v243
    v_mul_f32 v24, v24, v243
    v_mul_f32 v25, v25, v243
    v_mul_f32 v26, v26, v243
    v_mul_f32 v27, v27, v243
    v_mul_f32 v28, v28, v243
    v_mul_f32 v29, v29, v243
    v_mul_f32 v30, v30, v243
    v_mul_f32 v31, v31, v243
    v_mul_f32 v32, v32, v243
    v_mul_f32 v33, v33, v243
    v_mul_f32 v34, v34, v243
    v_mul_f32 v35, v35, v243
    v_mul_f32 v36, v36, v243
    v_mul_f32 v37, v37, v243
    v_mul_f32 v38, v38, v243
    v_mul_f32 v39, v39, v243
    v_mul_f32 v40, v40, v243
    v_mul_f32 v41, v41, v243
    v_mul_f32 v42, v42, v243
    v_mul_f32 v43, v43, v243
    v_mul_f32 v44, v44, v243
    v_mul_f32 v45, v45, v243
    v_mul_f32 v46, v46, v243
    v_mul_f32 v47, v47, v243
    v_mul_f32 v48, v48, v243
    v_mul_f32 v49, v49, v243
    v_mul_f32 v50, v50, v243
    v_mul_f32 v51, v51, v243
    v_mul_f32 v52, v52, v243
    v_mul_f32 v53, v53, v243
    v_mul_f32 v54, v54, v243
    v_mul_f32 v55, v55, v243
    v_mul_f32 v56, v56, v243
    v_mul_f32 v57, v57, v243
    v_mul_f32 v58, v58, v243
    v_mul_f32 v59, v59, v243
    v_mul_f32 v60, v60, v243
    v_mul_f32 v61, v61, v243
    v_mul_f32 v62, v62, v243
    v_mul_f32 v63, v63, v243
    v_mov_b32 v244, v243
    v_mov_b32 v242, v243
    s_nop 1
    v_permlane16_swap_b32 v244, v242
    v_mul_f32 v238, v238, v243
    v_mul_f32 v239, v239, v242
    s_nop 1
    s_branch L1_back1
L1_rare2:
    s_nop 15
    v_max_f32 v244, 0, v242
    v_exp_f32 v243, -v244
    v_sub_f32 v96, v96, v244
    v_sub_f32 v97, v97, v244
    v_sub_f32 v98, v98, v244
    v_sub_f32 v99, v99, v244
    v_sub_f32 v100, v100, v244
    v_sub_f32 v101, v101, v244
    v_sub_f32 v102, v102, v244
    v_sub_f32 v103, v103, v244
    v_sub_f32 v104, v104, v244
    v_sub_f32 v105, v105, v244
    v_sub_f32 v106, v106, v244
    v_sub_f32 v107, v107, v244
    v_sub_f32 v108, v108, v244
    v_sub_f32 v109, v109, v244
    v_sub_f32 v110, v110, v244
    v_sub_f32 v111, v111, v244
    v_sub_f32 v112, v112, v244
    v_sub_f32 v113, v113, v244
    v_sub_f32 v114, v114, v244
    v_sub_f32 v115, v115, v244
    v_sub_f32 v116, v116, v244
    v_sub_f32 v117, v117, v244
    v_sub_f32 v118, v118, v244
    v_sub_f32 v119, v119, v244
    v_sub_f32 v120, v120, v244
    v_sub_f32 v121, v121, v244
    v_sub_f32 v122, v122, v244
    v_sub_f32 v123, v123, v244
    v_sub_f32 v124, v124, v244
    v_sub_f32 v125, v125, v244
    v_sub_f32 v126, v126, v244
    v_sub_f32 v127, v127, v244
    v_sub_f32 v176, v176, v244
    v_sub_f32 v177, v177, v244
    v_sub_f32 v178, v178, v244
    v_sub_f32 v179, v179, v244
    v_sub_f32 v180, v180, v244
    v_sub_f32 v181, v181, v244
    v_sub_f32 v182, v182, v244
    v_sub_f32 v183, v183, v244
    v_sub_f32 v184, v184, v244
    v_sub_f32 v185, v185, v244
    v_sub_f32 v186, v186, v244
    v_sub_f32 v187, v187, v244
    v_sub_f32 v188, v188, v244
    v_sub_f32 v189, v189, v244
    v_sub_f32 v190, v190, v244
    v_sub_f32 v191, v191, v244
    v_mul_f32 v0, v0, v243
    v_mul_f32 v1, v1, v243
    v_mul_f32 v2, v2, v243
    v_mul_f32 v3, v3, v243
    v_mul_f32 v4, v4, v243
    v_mul_f32 v5, v5, v243
    v_mul_f32 v6, v6, v243
    v_mul_f32 v7, v7, v243
    v_mul_f32 v8, v8, v243
    v_mul_f32 v9, v9, v243
    v_mul_f32 v10, v10, v243
    v_mul_f32 v11, v11, v243
    v_mul_f32 v12, v12, v243
    v_mul_f32 v13, v13, v243
    v_mul_f32 v14, v14, v243
    v_mul_f32 v15, v15, v243
    v_mul_f32 v16, v16, v243
    v_mul_f32 v17, v17, v243
    v_mul_f32 v18, v18, v243
    v_mul_f32 v19, v19, v243
    v_mul_f32 v20, v20, v243
    v_mul_f32 v21, v21, v243
    v_mul_f32 v22, v22, v243
    v_mul_f32 v23, v23, v243
    v_mul_f32 v24, v24, v243
    v_mul_f32 v25, v25, v243
    v_mul_f32 v26, v26, v243
    v_mul_f32 v27, v27, v243
    v_mul_f32 v28, v28, v243
    v_mul_f32 v29, v29, v243
    v_mul_f32 v30, v30, v243
    v_mul_f32 v31, v31, v243
    v_mul_f32 v32, v32, v243
    v_mul_f32 v33, v33, v243
    v_mul_f32 v34, v34, v243
    v_mul_f32 v35, v35, v243
    v_mul_f32 v36, v36, v243
    v_mul_f32 v37, v37, v243
    v_mul_f32 v38, v38, v243
    v_mul_f32 v39, v39, v243
    v_mul_f32 v40, v40, v243
    v_mul_f32 v41, v41, v243
    v_mul_f32 v42, v42, v243
    v_mul_f32 v43, v43, v243
    v_mul_f32 v44, v44, v243
    v_mul_f32 v45, v45, v243
    v_mul_f32 v46, v46, v243
    v_mul_f32 v47, v47, v243
    v_mul_f32 v48, v48, v243
    v_mul_f32 v49, v49, v243
    v_mul_f32 v50, v50, v243
    v_mul_f32 v51, v51, v243
    v_mul_f32 v52, v52, v243
    v_mul_f32 v53, v53, v243
    v_mul_f32 v54, v54, v243
    v_mul_f32 v55, v55, v243
    v_mul_f32 v56, v56, v243
    v_mul_f32 v57, v57, v243
    v_mul_f32 v58, v58, v243
    v_mul_f32 v59, v59, v243
    v_mul_f32 v60, v60, v243
    v_mul_f32 v61, v61, v243
    v_mul_f32 v62, v62, v243
    v_mul_f32 v63, v63, v243
    v_mov_b32 v244, v243
    v_mov_b32 v242, v243
    s_nop 1
    v_permlane16_swap_b32 v244, v242
    v_mul_f32 v238, v238, v243
    v_mul_f32 v239, v239, v242
    s_nop 1
    s_branch L1_back2
L1_rare3:
    s_nop 15
    v_max_f32 v244, 0, v242
    v_exp_f32 v243, -v244
    v_sub_f32 v128, v128, v244
    v_sub_f32 v129, v129, v244
    v_sub_f32 v130, v130, v244
    v_sub_f32 v131, v131, v244
    v_sub_f32 v132, v132, v244
    v_sub_f32 v133, v133, v244
    v_sub_f32 v134, v134, v244
    v_sub_f32 v135, v135, v244
    v_sub_f32 v136, v136, v244
    v_sub_f32 v137, v137, v244
    v_sub_f32 v138, v138, v244
    v_sub_f32 v139, v139, v244
    v_sub_f32 v140, v140, v244
    v_sub_f32 v141, v141, v244
    v_sub_f32 v142, v142, v244
    v_sub_f32 v143, v143, v244
    v_sub_f32 v144, v144, v244
    v_sub_f32 v145, v145, v244
    v_sub_f32 v146, v146, v244
    v_sub_f32 v147, v147, v244
    v_sub_f32 v148, v148, v244
    v_sub_f32 v149, v149, v244
    v_sub_f32 v150, v150, v244
    v_sub_f32 v151, v151, v244
    v_sub_f32 v152, v152, v244
    v_sub_f32 v153, v153, v244
    v_sub_f32 v154, v154, v244
    v_sub_f32 v155, v155, v244
    v_sub_f32 v156, v156, v244
    v_sub_f32 v157, v157, v244
    v_sub_f32 v158, v158, v244
    v_sub_f32 v159, v159, v244
    v_sub_f32 v176, v176, v244
    v_sub_f32 v177, v177, v244
    v_sub_f32 v178, v178, v244
    v_sub_f32 v179, v179, v244
    v_sub_f32 v180, v180, v244
    v_sub_f32 v181, v181, v244
    v_sub_f32 v182, v182, v244
    v_sub_f32 v183, v183, v244
    v_sub_f32 v184, v184, v244
    v_sub_f32 v185, v185, v244
    v_sub_f32 v186, v186, v244
    v_sub_f32 v187, v187, v244
    v_sub_f32 v188, v188, v244
    v_sub_f32 v189, v189, v244
    v_sub_f32 v190, v190, v244
    v_sub_f32 v191, v191, v244
    v_mul_f32 v0, v0, v243
    v_mul_f32 v1, v1, v243
    v_mul_f32 v2, v2, v243
    v_mul_f32 v3, v3, v243
    v_mul_f32 v4, v4, v243
    v_mul_f32 v5, v5, v243
    v_mul_f32 v6, v6, v243
    v_mul_f32 v7, v7, v243
    v_mul_f32 v8, v8, v243
    v_mul_f32 v9, v9, v243
    v_mul_f32 v10, v10, v243
    v_mul_f32 v11, v11, v243
    v_mul_f32 v12, v12, v243
    v_mul_f32 v13, v13, v243
    v_mul_f32 v14, v14, v243
    v_mul_f32 v15, v15, v243
    v_mul_f32 v16, v16, v243
    v_mul_f32 v17, v17, v243
    v_mul_f32 v18, v18, v243
    v_mul_f32 v19, v19, v243
    v_mul_f32 v20, v20, v243
    v_mul_f32 v21, v21, v243
    v_mul_f32 v22, v22, v243
    v_mul_f32 v23, v23, v243
    v_mul_f32 v24, v24, v243
    v_mul_f32 v25, v25, v243
    v_mul_f32 v26, v26, v243
    v_mul_f32 v27, v27, v243
    v_mul_f32 v28, v28, v243
    v_mul_f32 v29, v29, v243
    v_mul_f32 v30, v30, v243
    v_mul_f32 v31, v31, v243
    v_mul_f32 v32, v32, v243
    v_mul_f32 v33, v33, v243
    v_mul_f32 v34, v34, v243
    v_mul_f32 v35, v35, v243
    v_mul_f32 v36, v36, v243
    v_mul_f32 v37, v37, v243
    v_mul_f32 v38, v38, v243
    v_mul_f32 v39, v39, v243
    v_mul_f32 v40, v40, v243
    v_mul_f32 v41, v41, v243
    v_mul_f32 v42, v42, v243
    v_mul_f32 v43, v43, v243
    v_mul_f32 v44, v44, v243
    v_mul_f32 v45, v45, v243
    v_mul_f32 v46, v46, v243
    v_mul_f32 v47, v47, v243
    v_mul_f32 v48, v48, v243
    v_mul_f32 v49, v49, v243
    v_mul_f32 v50, v50, v243
    v_mul_f32 v51, v51, v243
    v_mul_f32 v52, v52, v243
    v_mul_f32 v53, v53, v243
    v_mul_f32 v54, v54, v243
    v_mul_f32 v55, v55, v243
    v_mul_f32 v56, v56, v243
    v_mul_f32 v57, v57, v243
    v_mul_f32 v58, v58, v243
    v_mul_f32 v59, v59, v243
    v_mul_f32 v60, v60, v243
    v_mul_f32 v61, v61, v243
    v_mul_f32 v62, v62, v243
    v_mul_f32 v63, v63, v243
    v_mov_b32 v244, v243
    v_mov_b32 v242, v243
    s_nop 1
    v_permlane16_swap_b32 v244, v242
    v_mul_f32 v238, v238, v243
    v_mul_f32 v239, v239, v242
    s_nop 1
    s_branch L1_back3
L1_rare4:
    s_nop 15
    v_max_f32 v244, 0, v242
    v_exp_f32 v243, -v244
    v_sub_f32 v96, v96, v244
    v_sub_f32 v97, v97, v244
    v_sub_f32 v98, v98, v244
    v_sub_f32 v99, v99, v244
    v_sub_f32 v100, v100, v244
    v_sub_f32 v101, v101, v244
    v_sub_f32 v102, v102, v244
    v_sub_f32 v103, v103, v244
    v_sub_f32 v104, v104, v244
    v_sub_f32 v105, v105, v244
    v_sub_f32 v106, v106, v244
    v_sub_f32 v107, v107, v244
    v_sub_f32 v108, v108, v244
    v_sub_f32 v109, v109, v244
    v_sub_f32 v110, v110, v244
    v_sub_f32 v111, v111, v244
    v_sub_f32 v112, v112, v244
    v_sub_f32 v113, v113, v244
    v_sub_f32 v114, v114, v244
    v_sub_f32 v115, v115, v244
    v_sub_f32 v116, v116, v244
    v_sub_f32 v117, v117, v244
    v_sub_f32 v118, v118, v244
    v_sub_f32 v119, v119, v244
    v_sub_f32 v120, v120, v244
    v_sub_f32 v121, v121, v244
    v_sub_f32 v122, v122, v244
    v_sub_f32 v123, v123, v244
    v_sub_f32 v124, v124, v244
    v_sub_f32 v125, v125, v244
    v_sub_f32 v126, v126, v244
    v_sub_f32 v127, v127, v244
    v_sub_f32 v176, v176, v244
    v_sub_f32 v177, v177, v244
    v_sub_f32 v178, v178, v244
    v_sub_f32 v179, v179, v244
    v_sub_f32 v180, v180, v244
    v_sub_f32 v181, v181, v244
    v_sub_f32 v182, v182, v244
    v_sub_f32 v183, v183, v244
    v_sub_f32 v184, v184, v244
    v_sub_f32 v185, v185, v244
    v_sub_f32 v186, v186, v244
    v_sub_f32 v187, v187, v244
    v_sub_f32 v188, v188, v244
    v_sub_f32 v189, v189, v244
    v_sub_f32 v190, v190, v244
    v_sub_f32 v191, v191, v244
    v_mul_f32 v0, v0, v243
    v_mul_f32 v1, v1, v243
    v_mul_f32 v2, v2, v243
    v_mul_f32 v3, v3, v243
    v_mul_f32 v4, v4, v243
    v_mul_f32 v5, v5, v243
    v_mul_f32 v6, v6, v243
    v_mul_f32 v7, v7, v243
    v_mul_f32 v8, v8, v243
    v_mul_f32 v9, v9, v243
    v_mul_f32 v10, v10, v243
    v_mul_f32 v11, v11, v243
    v_mul_f32 v12, v12, v243
    v_mul_f32 v13, v13, v243
    v_mul_f32 v14, v14, v243
    v_mul_f32 v15, v15, v243
    v_mul_f32 v16, v16, v243
    v_mul_f32 v17, v17, v243
    v_mul_f32 v18, v18, v243
    v_mul_f32 v19, v19, v243
    v_mul_f32 v20, v20, v243
    v_mul_f32 v21, v21, v243
    v_mul_f32 v22, v22, v243
    v_mul_f32 v23, v23, v243
    v_mul_f32 v24, v24, v243
    v_mul_f32 v25, v25, v243
    v_mul_f32 v26, v26, v243
    v_mul_f32 v27, v27, v243
    v_mul_f32 v28, v28, v243
    v_mul_f32 v29, v29, v243
    v_mul_f32 v30, v30, v243
    v_mul_f32 v31, v31, v243
    v_mul_f32 v32, v32, v243
    v_mul_f32 v33, v33, v243
    v_mul_f32 v34, v34, v243
    v_mul_f32 v35, v35, v243
    v_mul_f32 v36, v36, v243
    v_mul_f32 v37, v37, v243
    v_mul_f32 v38, v38, v243
    v_mul_f32 v39, v39, v243
    v_mul_f32 v40, v40, v243
    v_mul_f32 v41, v41, v243
    v_mul_f32 v42, v42, v243
    v_mul_f32 v43, v43, v243
    v_mul_f32 v44, v44, v243
    v_mul_f32 v45, v45, v243
    v_mul_f32 v46, v46, v243
    v_mul_f32 v47, v47, v243
    v_mul_f32 v48, v48, v243
    v_mul_f32 v49, v49, v243
    v_mul_f32 v50, v50, v243
    v_mul_f32 v51, v51, v243
    v_mul_f32 v52, v52, v243
    v_mul_f32 v53, v53, v243
    v_mul_f32 v54, v54, v243
    v_mul_f32 v55, v55, v243
    v_mul_f32 v56, v56, v243
    v_mul_f32 v57, v57, v243
    v_mul_f32 v58, v58, v243
    v_mul_f32 v59, v59, v243
    v_mul_f32 v60, v60, v243
    v_mul_f32 v61, v61, v243
    v_mul_f32 v62, v62, v243
    v_mul_f32 v63, v63, v243
    v_mov_b32 v244, v243
    v_mov_b32 v242, v243
    s_nop 1
    v_permlane16_swap_b32 v244, v242
    v_mul_f32 v238, v238, v243
    v_mul_f32 v239, v239, v242
    s_nop 1
    s_branch L1_back4
L1_rare5:
    s_nop 15
    v_max_f32 v244, 0, v242
    v_exp_f32 v243, -v244
    v_sub_f32 v128, v128, v244
    v_sub_f32 v129, v129, v244
    v_sub_f32 v130, v130, v244
    v_sub_f32 v131, v131, v244
    v_sub_f32 v132, v132, v244
    v_sub_f32 v133, v133, v244
    v_sub_f32 v134, v134, v244
    v_sub_f32 v135, v135, v244
    v_sub_f32 v136, v136, v244
    v_sub_f32 v137, v137, v244
    v_sub_f32 v138, v138, v244
    v_sub_f32 v139, v139, v244
    v_sub_f32 v140, v140, v244
    v_sub_f32 v141, v141, v244
    v_sub_f32 v142, v142, v244
    v_sub_f32 v143, v143, v244
    v_sub_f32 v144, v144, v244
    v_sub_f32 v145, v145, v244
    v_sub_f32 v146, v146, v244
    v_sub_f32 v147, v147, v244
    v_sub_f32 v148, v148, v244
    v_sub_f32 v149, v149, v244
    v_sub_f32 v150, v150, v244
    v_sub_f32 v151, v151, v244
    v_sub_f32 v152, v152, v244
    v_sub_f32 v153, v153, v244
    v_sub_f32 v154, v154, v244
    v_sub_f32 v155, v155, v244
    v_sub_f32 v156, v156, v244
    v_sub_f32 v157, v157, v244
    v_sub_f32 v158, v158, v244
    v_sub_f32 v159, v159, v244
    v_sub_f32 v176, v176, v244
    v_sub_f32 v177, v177, v244
    v_sub_f32 v178, v178, v244
    v_sub_f32 v179, v179, v244
    v_sub_f32 v180, v180, v244
    v_sub_f32 v181, v181, v244
    v_sub_f32 v182, v182, v244
    v_sub_f32 v183, v183, v244
    v_sub_f32 v184, v184, v244
    v_sub_f32 v185, v185, v244
    v_sub_f32 v186, v186, v244
    v_sub_f32 v187, v187, v244
    v_sub_f32 v188, v188, v244
    v_sub_f32 v189, v189, v244
    v_sub_f32 v190, v190, v244
    v_sub_f32 v191, v191, v244
    v_mul_f32 v0, v0, v243
    v_mul_f32 v1, v1, v243
    v_mul_f32 v2, v2, v243
    v_mul_f32 v3, v3, v243
    v_mul_f32 v4, v4, v243
    v_mul_f32 v5, v5, v243
    v_mul_f32 v6, v6, v243
    v_mul_f32 v7, v7, v243
    v_mul_f32 v8, v8, v243
    v_mul_f32 v9, v9, v243
    v_mul_f32 v10, v10, v243
    v_mul_f32 v11, v11, v243
    v_mul_f32 v12, v12, v243
    v_mul_f32 v13, v13, v243
    v_mul_f32 v14, v14, v243
    v_mul_f32 v15, v15, v243
    v_mul_f32 v16, v16, v243
    v_mul_f32 v17, v17, v243
    v_mul_f32 v18, v18, v243
    v_mul_f32 v19, v19, v243
    v_mul_f32 v20, v20, v243
    v_mul_f32 v21, v21, v243
    v_mul_f32 v22, v22, v243
    v_mul_f32 v23, v23, v243
    v_mul_f32 v24, v24, v243
    v_mul_f32 v25, v25, v243
    v_mul_f32 v26, v26, v243
    v_mul_f32 v27, v27, v243
    v_mul_f32 v28, v28, v243
    v_mul_f32 v29, v29, v243
    v_mul_f32 v30, v30, v243
    v_mul_f32 v31, v31, v243
    v_mul_f32 v32, v32, v243
    v_mul_f32 v33, v33, v243
    v_mul_f32 v34, v34, v243
    v_mul_f32 v35, v35, v243
    v_mul_f32 v36, v36, v243
    v_mul_f32 v37, v37, v243
    v_mul_f32 v38, v38, v243
    v_mul_f32 v39, v39, v243
    v_mul_f32 v40, v40, v243
    v_mul_f32 v41, v41, v243
    v_mul_f32 v42, v42, v243
    v_mul_f32 v43, v43, v243
    v_mul_f32 v44, v44, v243
    v_mul_f32 v45, v45, v243
    v_mul_f32 v46, v46, v243
    v_mul_f32 v47, v47, v243
    v_mul_f32 v48, v48, v243
    v_mul_f32 v49, v49, v243
    v_mul_f32 v50, v50, v243
    v_mul_f32 v51, v51, v243
    v_mul_f32 v52, v52, v243
    v_mul_f32 v53, v53, v243
    v_mul_f32 v54, v54, v243
    v_mul_f32 v55, v55, v243
    v_mul_f32 v56, v56, v243
    v_mul_f32 v57, v57, v243
    v_mul_f32 v58, v58, v243
    v_mul_f32 v59, v59, v243
    v_mul_f32 v60, v60, v243
    v_mul_f32 v61, v61, v243
    v_mul_f32 v62, v62, v243
    v_mul_f32 v63, v63, v243
    v_mov_b32 v244, v243
    v_mov_b32 v242, v243
    s_nop 1
    v_permlane16_swap_b32 v244, v242
    v_mul_f32 v238, v238, v243
    v_mul_f32 v239, v239, v242
    s_nop 1
    s_branch L1_back5
L1_rare6:
    s_nop 15
    v_max_f32 v244, 0, v242
    v_exp_f32 v243, -v244
    v_sub_f32 v96, v96, v244
    v_sub_f32 v97, v97, v244
    v_sub_f32 v98, v98, v244
    v_sub_f32 v99, v99, v244
    v_sub_f32 v100, v100, v244
    v_sub_f32 v101, v101, v244
    v_sub_f32 v102, v102, v244
    v_sub_f32 v103, v103, v244
    v_sub_f32 v104, v104, v244
    v_sub_f32 v105, v105, v244
    v_sub_f32 v106, v106, v244
    v_sub_f32 v107, v107, v244
    v_sub_f32 v108, v108, v244
    v_sub_f32 v109, v109, v244
    v_sub_f32 v110, v110, v244
    v_sub_f32 v111, v111, v244
    v_sub_f32 v112, v112, v244
    v_sub_f32 v113, v113, v244
    v_sub_f32 v114, v114, v244
    v_sub_f32 v115, v115, v244
    v_sub_f32 v116, v116, v244
    v_sub_f32 v117, v117, v244
    v_sub_f32 v118, v118, v244
    v_sub_f32 v119, v119, v244
    v_sub_f32 v120, v120, v244
    v_sub_f32 v121, v121, v244
    v_sub_f32 v122, v122, v244
    v_sub_f32 v123, v123, v244
    v_sub_f32 v124, v124, v244
    v_sub_f32 v125, v125, v244
    v_sub_f32 v126, v126, v244
    v_sub_f32 v127, v127, v244
    v_sub_f32 v176, v176, v244
    v_sub_f32 v177, v177, v244
    v_sub_f32 v178, v178, v244
    v_sub_f32 v179, v179, v244
    v_sub_f32 v180, v180, v244
    v_sub_f32 v181, v181, v244
    v_sub_f32 v182, v182, v244
    v_sub_f32 v183, v183, v244
    v_sub_f32 v184, v184, v244
    v_sub_f32 v185, v185, v244
    v_sub_f32 v186, v186, v244
    v_sub_f32 v187, v187, v244
    v_sub_f32 v188, v188, v244
    v_sub_f32 v189, v189, v244
    v_sub_f32 v190, v190, v244
    v_sub_f32 v191, v191, v244
    v_mul_f32 v0, v0, v243
    v_mul_f32 v1, v1, v243
    v_mul_f32 v2, v2, v243
    v_mul_f32 v3, v3, v243
    v_mul_f32 v4, v4, v243
    v_mul_f32 v5, v5, v243
    v_mul_f32 v6, v6, v243
    v_mul_f32 v7, v7, v243
    v_mul_f32 v8, v8, v243
    v_mul_f32 v9, v9, v243
    v_mul_f32 v10, v10, v243
    v_mul_f32 v11, v11, v243
    v_mul_f32 v12, v12, v243
    v_mul_f32 v13, v13, v243
    v_mul_f32 v14, v14, v243
    v_mul_f32 v15, v15, v243
    v_mul_f32 v16, v16, v243
    v_mul_f32 v17, v17, v243
    v_mul_f32 v18, v18, v243
    v_mul_f32 v19, v19, v243
    v_mul_f32 v20, v20, v243
    v_mul_f32 v21, v21, v243
    v_mul_f32 v22, v22, v243
    v_mul_f32 v23, v23, v243
    v_mul_f32 v24, v24, v243
    v_mul_f32 v25, v25, v243
    v_mul_f32 v26, v26, v243
    v_mul_f32 v27, v27, v243
    v_mul_f32 v28, v28, v243
    v_mul_f32 v29, v29, v243
    v_mul_f32 v30, v30, v243
    v_mul_f32 v31, v31, v243
    v_mul_f32 v32, v32, v243
    v_mul_f32 v33, v33, v243
    v_mul_f32 v34, v34, v243
    v_mul_f32 v35, v35, v243
    v_mul_f32 v36, v36, v243
    v_mul_f32 v37, v37, v243
    v_mul_f32 v38, v38, v243
    v_mul_f32 v39, v39, v243
    v_mul_f32 v40, v40, v243
    v_mul_f32 v41, v41, v243
    v_mul_f32 v42, v42, v243
    v_mul_f32 v43, v43, v243
    v_mul_f32 v44, v44, v243
    v_mul_f32 v45, v45, v243
    v_mul_f32 v46, v46, v243
    v_mul_f32 v47, v47, v243
    v_mul_f32 v48, v48, v243
    v_mul_f32 v49, v49, v243
    v_mul_f32 v50, v50, v243
    v_mul_f32 v51, v51, v243
    v_mul_f32 v52, v52, v243
    v_mul_f32 v53, v53, v243
    v_mul_f32 v54, v54, v243
    v_mul_f32 v55, v55, v243
    v_mul_f32 v56, v56, v243
    v_mul_f32 v57, v57, v243
    v_mul_f32 v58, v58, v243
    v_mul_f32 v59, v59, v243
    v_mul_f32 v60, v60, v243
    v_mul_f32 v61, v61, v243
    v_mul_f32 v62, v62, v243
    v_mul_f32 v63, v63, v243
    v_mov_b32 v244, v243
    v_mov_b32 v242, v243
    s_nop 1
    v_permlane16_swap_b32 v244, v242
    v_mul_f32 v238, v238, v243
    v_mul_f32 v239, v239, v242
    s_nop 1
    s_branch L1_back6
L1_rare7:
    s_nop 15
    v_max_f32 v244, 0, v242
    v_exp_f32 v243, -v244
    v_sub_f32 v128, v128, v244
    v_sub_f32 v129, v129, v244
    v_sub_f32 v130, v130, v244
    v_sub_f32 v131, v131, v244
    v_sub_f32 v132, v132, v244
    v_sub_f32 v133, v133, v244
    v_sub_f32 v134, v134, v244
    v_sub_f32 v135, v135, v244
    v_sub_f32 v136, v136, v244
    v_sub_f32 v137, v137, v244
    v_sub_f32 v138, v138, v244
    v_sub_f32 v139, v139, v244
    v_sub_f32 v140, v140, v244
    v_sub_f32 v141, v141, v244
    v_sub_f32 v142, v142, v244
    v_sub_f32 v143, v143, v244
    v_sub_f32 v144, v144, v244
    v_sub_f32 v145, v145, v244
    v_sub_f32 v146, v146, v244
    v_sub_f32 v147, v147, v244
    v_sub_f32 v148, v148, v244
    v_sub_f32 v149, v149, v244
    v_sub_f32 v150, v150, v244
    v_sub_f32 v151, v151, v244
    v_sub_f32 v152, v152, v244
    v_sub_f32 v153, v153, v244
    v_sub_f32 v154, v154, v244
    v_sub_f32 v155, v155, v244
    v_sub_f32 v156, v156, v244
    v_sub_f32 v157, v157, v244
    v_sub_f32 v158, v158, v244
    v_sub_f32 v159, v159, v244
    v_sub_f32 v176, v176, v244
    v_sub_f32 v177, v177, v244
    v_sub_f32 v178, v178, v244
    v_sub_f32 v179, v179, v244
    v_sub_f32 v180, v180, v244
    v_sub_f32 v181, v181, v244
    v_sub_f32 v182, v182, v244
    v_sub_f32 v183, v183, v244
    v_sub_f32 v184, v184, v244
    v_sub_f32 v185, v185, v244
    v_sub_f32 v186, v186, v244
    v_sub_f32 v187, v187, v244
    v_sub_f32 v188, v188, v244
    v_sub_f32 v189, v189, v244
    v_sub_f32 v190, v190, v244
    v_sub_f32 v191, v191, v244
    v_mul_f32 v0, v0, v243
    v_mul_f32 v1, v1, v243
    v_mul_f32 v2, v2, v243
    v_mul_f32 v3, v3, v243
    v_mul_f32 v4, v4, v243
    v_mul_f32 v5, v5, v243
    v_mul_f32 v6, v6, v243
    v_mul_f32 v7, v7, v243
    v_mul_f32 v8, v8, v243
    v_mul_f32 v9, v9, v243
    v_mul_f32 v10, v10, v243
    v_mul_f32 v11, v11, v243
    v_mul_f32 v12, v12, v243
    v_mul_f32 v13, v13, v243
    v_mul_f32 v14, v14, v243
    v_mul_f32 v15, v15, v243
    v_mul_f32 v16, v16, v243
    v_mul_f32 v17, v17, v243
    v_mul_f32 v18, v18, v243
    v_mul_f32 v19, v19, v243
    v_mul_f32 v20, v20, v243
    v_mul_f32 v21, v21, v243
    v_mul_f32 v22, v22, v243
    v_mul_f32 v23, v23, v243
    v_mul_f32 v24, v24, v243
    v_mul_f32 v25, v25, v243
    v_mul_f32 v26, v26, v243
    v_mul_f32 v27, v27, v243
    v_mul_f32 v28, v28, v243
    v_mul_f32 v29, v29, v243
    v_mul_f32 v30, v30, v243
    v_mul_f32 v31, v31, v243
    v_mul_f32 v32, v32, v243
    v_mul_f32 v33, v33, v243
    v_mul_f32 v34, v34, v243
    v_mul_f32 v35, v35, v243
    v_mul_f32 v36, v36, v243
    v_mul_f32 v37, v37, v243
    v_mul_f32 v38, v38, v243
    v_mul_f32 v39, v39, v243
    v_mul_f32 v40, v40, v243
    v_mul_f32 v41, v41, v243
    v_mul_f32 v42, v42, v243
    v_mul_f32 v43, v43, v243
    v_mul_f32 v44, v44, v243
    v_mul_f32 v45, v45, v243
    v_mul_f32 v46, v46, v243
    v_mul_f32 v47, v47, v243
    v_mul_f32 v48, v48, v243
    v_mul_f32 v49, v49, v243
    v_mul_f32 v50, v50, v243
    v_mul_f32 v51, v51, v243
    v_mul_f32 v52, v52, v243
    v_mul_f32 v53, v53, v243
    v_mul_f32 v54, v54, v243
    v_mul_f32 v55, v55, v243
    v_mul_f32 v56, v56, v243
    v_mul_f32 v57, v57, v243
    v_mul_f32 v58, v58, v243
    v_mul_f32 v59, v59, v243
    v_mul_f32 v60, v60, v243
    v_mul_f32 v61, v61, v243
    v_mul_f32 v62, v62, v243
    v_mul_f32 v63, v63, v243
    v_mov_b32 v244, v243
    v_mov_b32 v242, v243
    s_nop 1
    v_permlane16_swap_b32 v244, v242
    v_mul_f32 v238, v238, v243
    v_mul_f32 v239, v239, v242
    s_nop 1
    s_branch L1_back7
.globl concat_oproj_kernel
.p2align 8
.type concat_oproj_kernel,@function
concat_oproj_kernel:
    s_cmp_ge_u32 s2, 256
    s_cbranch_scc1 L2_exit
    s_load_dwordx16 s[36:51], s[0:1], 0
    s_load_dwordx4 s[52:55], s[0:1], 64
    s_load_dwordx2 s[56:57], s[0:1], 80
    s_load_dwordx2 s[58:59], s[0:1], 96
    s_and_b32 s60, s2, 7
    s_lshr_b32 s61, s2, 3
    s_and_b32 s62, s61, 3
    s_lshr_b32 s61, s61, 2
    s_lshl_b32 s60, s60, 3
    s_add_u32 s60, s60, s61
    s_lshr_b32 s61, s60, 5
    v_mov_b32 v148, v0
    v_lshrrev_b32 v150, 6, v148
    v_and_b32 v149, 63, v148
    v_readfirstlane_b32 s28, v150
    s_waitcnt lgkmcnt(0)
    s_mul_i32 s63, s61, 4718592
    s_add_u32 s63, s63, 67108864
    s_add_u32 s8, s58, s63
    s_addc_u32 s9, s59, 0
    s_mov_b32 s10, 4718592
    s_mov_b32 s11, 0x00020000
    s_lshl_b32 s63, s60, 19
    s_add_u32 s4, s58, s63
    s_addc_u32 s5, s59, 0
    s_mov_b32 s6, 524288
    s_mov_b32 s7, 0x00020000
    s_mov_b32 s12, s56
    s_mov_b32 s13, s57
    s_mov_b32 s14, 4718592
    s_mov_b32 s15, 0x00020000
    s_mul_i32 s24, s28, 36864
    s_lshl_b32 s25, s28, 16
    s_mul_i32 s26, s28, 294912
    v_lshrrev_b32 v150, 5, v149
    v_lshlrev_b32 v150, 10, v150
    v_bfe_u32 v151, v149, 4, 1
    v_lshl_add_u32 v150, v151, 9, v150
    v_and_b32 v151, 15, v149
    v_lshl_add_u32 v136, v151, 4, v150
    v_add_u32 v137, 262144, v136
    s_mul_i32 s63, s62, 1179648
    s_mov_b32 s64, 0xe38e38e4
    v_add_u32 v150, 0, v149
    v_lshlrev_b32 v151, 4, v150
    v_add_u32 v138, s63, v151
    v_add_u32 v150, 64, v149
    v_lshlrev_b32 v151, 4, v150
    v_add_u32 v139, s63, v151
    v_add_u32 v150, 128, v149
    v_lshlrev_b32 v151, 4, v150
    v_add_u32 v140, s63, v151
    v_add_u32 v150, 192, v149
    v_lshlrev_b32 v151, 4, v150
    v_add_u32 v141, s63, v151
    v_add_u32 v150, 256, v149
    v_lshlrev_b32 v151, 4, v150
    v_add_u32 v142, s63, v151
    v_add_u32 v150, 320, v149
    v_lshlrev_b32 v151, 4, v150
    v_add_u32 v143, s63, v151
    v_add_u32 v150, 384, v149
    v_lshlrev_b32 v151, 4, v150
    v_add_u32 v144, s63, v151
    v_add_u32 v150, 448, v149
    v_lshlrev_b32 v151, 4, v150
    v_add_u32 v145, s63, v151
    v_add_u32 v150, 512, v149
    v_lshlrev_b32 v151, 4, v150
    v_add_u32 v146, s63, v151
    v_lshrrev_b32 v150, 4, v149
    v_bfe_u32 v151, v149, 2, 2
    v_lshl_add_u32 v150, v150, 3, v151
    v_mul_u32_u24 v150, 288, v150
    v_and_b32 v151, 3, v149
    v_lshl_add_u32 v150, v151, 3, v150
    v_add_u32 v147, s24, v150
    s_mov_b32 s30, s26
    s_mov_b32 s31, s25
    s_add_u32 m0, s24, 0
    s_nop 0
    buffer_load_dwordx4 v138, s[8:11], s30 offen lds
    s_add_u32 m0, s24, 1024
    s_nop 0
    buffer_load_dwordx4 v139, s[8:11], s30 offen lds
    s_add_u32 m0, s24, 2048
    s_nop 0
    buffer_load_dwordx4 v140, s[8:11], s30 offen lds
    s_add_u32 m0, s24, 3072
    s_nop 0
    buffer_load_dwordx4 v141, s[8:11], s30 offen lds
    s_add_u32 m0, s24, 4096
    s_nop 0
    buffer_load_dwordx4 v142, s[8:11], s30 offen lds
    s_add_u32 m0, s24, 5120
    s_nop 0
    buffer_load_dwordx4 v143, s[8:11], s30 offen lds
    s_add_u32 m0, s24, 6144
    s_nop 0
    buffer_load_dwordx4 v144, s[8:11], s30 offen lds
    s_add_u32 m0, s24, 7168
    s_nop 0
    buffer_load_dwordx4 v145, s[8:11], s30 offen lds
    s_add_u32 m0, s24, 8192
    s_nop 0
    buffer_load_dwordx4 v146, s[8:11], s30 offen lds
    s_add_u32 s30, s30, 9216
    s_add_u32 m0, s24, 9216
    s_nop 0
    buffer_load_dwordx4 v138, s[8:11], s30 offen lds
    s_add_u32 m0, s24, 10240
    s_nop 0
    buffer_load_dwordx4 v139, s[8:11], s30 offen lds
    s_add_u32 m0, s24, 11264
    s_nop 0
    buffer_load_dwordx4 v140, s[8:11], s30 offen lds
    s_add_u32 m0, s24, 12288
    s_nop 0
    buffer_load_dwordx4 v141, s[8:11], s30 offen lds
    s_add_u32 m0, s24, 13312
    s_nop 0
    buffer_load_dwordx4 v142, s[8:11], s30 offen lds
    s_add_u32 m0, s24, 14336
    s_nop 0
    buffer_load_dwordx4 v143, s[8:11], s30 offen lds
    s_add_u32 m0, s24, 15360
    s_nop 0
    buffer_load_dwordx4 v144, s[8:11], s30 offen lds
    s_add_u32 m0, s24, 16384
    s_nop 0
    buffer_load_dwordx4 v145, s[8:11], s30 offen lds
    s_add_u32 m0, s24, 17408
    s_nop 0
    buffer_load_dwordx4 v146, s[8:11], s30 offen lds
    s_add_u32 s30, s30, 9216
    buffer_load_dwordx4 v[0:3], v136, s[4:7], s31 offen
    buffer_load_dwordx4 v[4:7], v136, s[4:7], s31 offen offset:256
    buffer_load_dwordx4 v[8:11], v137, s[4:7], s31 offen
    buffer_load_dwordx4 v[12:15], v137, s[4:7], s31 offen offset:256
    s_add_u32 s31, s31, 2048
    s_add_u32 m0, s24, 18432
    s_nop 0
    buffer_load_dwordx4 v138, s[8:11], s30 offen lds
    s_add_u32 m0, s24, 19456
    s_nop 0
    buffer_load_dwordx4 v139, s[8:11], s30 offen lds
    s_add_u32 m0, s24, 20480
    s_nop 0
    buffer_load_dwordx4 v140, s[8:11], s30 offen lds
    s_add_u32 m0, s24, 21504
    s_nop 0
    buffer_load_dwordx4 v141, s[8:11], s30 offen lds
    s_add_u32 m0, s24, 22528
    s_nop 0
    buffer_load_dwordx4 v142, s[8:11], s30 offen lds
    s_add_u32 m0, s24, 23552
    s_nop 0
    buffer_load_dwordx4 v143, s[8:11], s30 offen lds
    s_add_u32 m0, s24, 24576
    s_nop 0
    buffer_load_dwordx4 v144, s[8:11], s30 offen lds
    s_add_u32 m0, s24, 25600
    s_nop 0
    buffer_load_dwordx4 v145, s[8:11], s30 offen lds
    s_add_u32 m0, s24, 26624
    s_nop 0
    buffer_load_dwordx4 v146, s[8:11], s30 offen lds
    s_add_u32 s30, s30, 9216
    buffer_load_dwordx4 v[16:19], v136, s[4:7], s31 offen
    buffer_load_dwordx4 v[20:23], v136, s[4:7], s31 offen offset:256
    buffer_load_dwordx4 v[24:27], v137, s[4:7], s31 offen
    buffer_load_dwordx4 v[28:31], v137, s[4:7], s31 offen offset:256
    s_add_u32 s31, s31, 2048
    s_add_u32 m0, s24, 27648
    s_nop 0
    buffer_load_dwordx4 v138, s[8:11], s30 offen lds
    s_add_u32 m0, s24, 28672
    s_nop 0
    buffer_load_dwordx4 v139, s[8:11], s30 offen lds
    s_add_u32 m0, s24, 29696
    s_nop 0
    buffer_load_dwordx4 v140, s[8:11], s30 offen lds
    s_add_u32 m0, s24, 30720
    s_nop 0
    buffer_load_dwordx4 v141, s[8:11], s30 offen lds
    s_add_u32 m0, s24, 31744
    s_nop 0
    buffer_load_dwordx4 v142, s[8:11], s30 offen lds
    s_add_u32 m0, s24, 32768
    s_nop 0
    buffer_load_dwordx4 v143, s[8:11], s30 offen lds
    s_add_u32 m0, s24, 33792
    s_nop 0
    buffer_load_dwordx4 v144, s[8:11], s30 offen lds
    s_add_u32 m0, s24, 34816
    s_nop 0
    buffer_load_dwordx4 v145, s[8:11], s30 offen lds
    s_add_u32 m0, s24, 35840
    s_nop 0
    buffer_load_dwordx4 v146, s[8:11], s30 offen lds
    s_add_u32 s30, s30, 9216
    buffer_load_dwordx4 v[32:35], v136, s[4:7], s31 offen
    buffer_load_dwordx4 v[36:39], v136, s[4:7], s31 offen offset:256
    buffer_load_dwordx4 v[40:43], v137, s[4:7], s31 offen
    buffer_load_dwordx4 v[44:47], v137, s[4:7], s31 offen offset:256
    s_add_u32 s31, s31, 2048
    s_waitcnt vmcnt(39)
    ds_read_b64_tr_b16 v[64:65], v147 offset:0
    ds_read_b64_tr_b16 v[66:67], v147 offset:1152
    ds_read_b64_tr_b16 v[68:69], v147 offset:32
    ds_read_b64_tr_b16 v[70:71], v147 offset:1184
    ds_read_b64_tr_b16 v[72:73], v147 offset:64
    ds_read_b64_tr_b16 v[74:75], v147 offset:1216
    ds_read_b64_tr_b16 v[76:77], v147 offset:96
    ds_read_b64_tr_b16 v[78:79], v147 offset:1248
    ds_read_b64_tr_b16 v[80:81], v147 offset:128
    ds_read_b64_tr_b16 v[82:83], v147 offset:1280
    ds_read_b64_tr_b16 v[84:85], v147 offset:160
    ds_read_b64_tr_b16 v[86:87], v147 offset:1312
    ds_read_b64_tr_b16 v[88:89], v147 offset:192
    ds_read_b64_tr_b16 v[90:91], v147 offset:1344
    ds_read_b64_tr_b16 v[92:93], v147 offset:224
    s_waitcnt lgkmcnt(13)
    ds_read_b64_tr_b16 v[94:95], v147 offset:1376
    ds_read_b64_tr_b16 v[96:97], v147 offset:256
    s_waitcnt lgkmcnt(13)
    ds_read_b64_tr_b16 v[98:99], v147 offset:1408
    s_waitcnt lgkmcnt(0)
    s_waitcnt vmcnt(26)
    v_mfma_f32_16x16x32_bf16 a[0:3], v[64:67], v[0:3], 0
    s_add_u32 m0, s24, 0
    s_nop 0
    buffer_load_dwordx4 v138, s[8:11], s30 offen lds
    v_mfma_f32_16x16x32_bf16 a[4:7], v[64:67], v[4:7], 0
    s_add_u32 m0, s24, 1024
    s_nop 0
    buffer_load_dwordx4 v139, s[8:11], s30 offen lds
    v_mfma_f32_16x16x32_bf16 a[8:11], v[64:67], v[8:11], 0
    s_add_u32 m0, s24, 2048
    s_nop 0
    buffer_load_dwordx4 v140, s[8:11], s30 offen lds
    v_mfma_f32_16x16x32_bf16 a[12:15], v[64:67], v[12:15], 0
    v_mfma_f32_16x16x32_bf16 a[16:19], v[68:71], v[0:3], 0
    s_add_u32 m0, s24, 3072
    s_nop 0
    buffer_load_dwordx4 v141, s[8:11], s30 offen lds
    v_mfma_f32_16x16x32_bf16 a[20:23], v[68:71], v[4:7], 0
    s_add_u32 m0, s24, 4096
    s_nop 0
    buffer_load_dwordx4 v142, s[8:11], s30 offen lds
    v_mfma_f32_16x16x32_bf16 a[24:27], v[68:71], v[8:11], 0
    s_add_u32 m0, s24, 5120
    s_nop 0
    buffer_load_dwordx4 v143, s[8:11], s30 offen lds
    v_mfma_f32_16x16x32_bf16 a[28:31], v[68:71], v[12:15], 0
    s_add_u32 m0, s24, 6144
    s_nop 0
    buffer_load_dwordx4 v144, s[8:11], s30 offen lds
    v_mfma_f32_16x16x32_bf16 a[32:35], v[72:75], v[0:3], 0
    s_add_u32 m0, s24, 7168
    s_nop 0
    buffer_load_dwordx4 v145, s[8:11], s30 offen lds
    v_mfma_f32_16x16x32_bf16 a[36:39], v[72:75], v[4:7], 0
    s_add_u32 m0, s24, 8192
    s_nop 0
    buffer_load_dwordx4 v146, s[8:11], s30 offen lds
    v_mfma_f32_16x16x32_bf16 a[40:43], v[72:75], v[8:11], 0
    s_add_u32 s30, s30, 9216
    v_mfma_f32_16x16x32_bf16 a[44:47], v[72:75], v[12:15], 0
    buffer_load_dwordx4 v[48:51], v136, s[4:7], s31 offen
    v_mfma_f32_16x16x32_bf16 a[48:51], v[76:79], v[0:3], 0
    buffer_load_dwordx4 v[52:55], v136, s[4:7], s31 offen offset:256
    v_mfma_f32_16x16x32_bf16 a[52:55], v[76:79], v[4:7], 0
    buffer_load_dwordx4 v[56:59], v137, s[4:7], s31 offen
    v_mfma_f32_16x16x32_bf16 a[56:59], v[76:79], v[8:11], 0
    buffer_load_dwordx4 v[60:63], v137, s[4:7], s31 offen offset:256
    v_mfma_f32_16x16x32_bf16 a[60:63], v[76:79], v[12:15], 0
    s_add_u32 s31, s31, 2048
    ds_read_b64_tr_b16 v[100:101], v147 offset:9216
    v_mfma_f32_16x16x32_bf16 a[64:67], v[80:83], v[0:3], 0
    v_mfma_f32_16x16x32_bf16 a[68:71], v[80:83], v[4:7], 0
    ds_read_b64_tr_b16 v[102:103], v147 offset:10368
    v_mfma_f32_16x16x32_bf16 a[72:75], v[80:83], v[8:11], 0
    ds_read_b64_tr_b16 v[104:105], v147 offset:9248
    v_mfma_f32_16x16x32_bf16 a[76:79], v[80:83], v[12:15], 0
    ds_read_b64_tr_b16 v[106:107], v147 offset:10400
    v_mfma_f32_16x16x32_bf16 a[80:83], v[84:87], v[0:3], 0
    ds_read_b64_tr_b16 v[108:109], v147 offset:9280
    v_mfma_f32_16x16x32_bf16 a[84:87], v[84:87], v[4:7], 0
    ds_read_b64_tr_b16 v[110:111], v147 offset:10432
    v_mfma_f32_16x16x32_bf16 a[88:91], v[84:87], v[8:11], 0
    ds_read_b64_tr_b16 v[112:113], v147 offset:9312
    v_mfma_f32_16x16x32_bf16 a[92:95], v[84:87], v[12:15], 0
    ds_read_b64_tr_b16 v[114:115], v147 offset:10464
    v_mfma_f32_16x16x32_bf16 a[96:99], v[88:91], v[0:3], 0
    v_mfma_f32_16x16x32_bf16 a[100:103], v[88:91], v[4:7], 0
    ds_read_b64_tr_b16 v[116:117], v147 offset:9344
    v_mfma_f32_16x16x32_bf16 a[104:107], v[88:91], v[8:11], 0
    ds_read_b64_tr_b16 v[118:119], v147 offset:10496
    v_mfma_f32_16x16x32_bf16 a[108:111], v[88:91], v[12:15], 0
    ds_read_b64_tr_b16 v[120:121], v147 offset:9376
    v_mfma_f32_16x16x32_bf16 a[112:115], v[92:95], v[0:3], 0
    ds_read_b64_tr_b16 v[122:123], v147 offset:10528
    v_mfma_f32_16x16x32_bf16 a[116:119], v[92:95], v[4:7], 0
    ds_read_b64_tr_b16 v[124:125], v147 offset:9408
    v_mfma_f32_16x16x32_bf16 a[120:123], v[92:95], v[8:11], 0
    ds_read_b64_tr_b16 v[126:127], v147 offset:10560
    v_mfma_f32_16x16x32_bf16 a[124:127], v[92:95], v[12:15], 0
    ds_read_b64_tr_b16 v[128:129], v147 offset:9440
    v_mfma_f32_16x16x32_bf16 a[128:131], v[96:99], v[0:3], 0
    v_mfma_f32_16x16x32_bf16 a[132:135], v[96:99], v[4:7], 0
    s_waitcnt lgkmcnt(13)
    ds_read_b64_tr_b16 v[130:131], v147 offset:10592
    v_mfma_f32_16x16x32_bf16 a[136:139], v[96:99], v[8:11], 0
    ds_read_b64_tr_b16 v[132:133], v147 offset:9472
    v_mfma_f32_16x16x32_bf16 a[140:143], v[96:99], v[12:15], 0
    s_waitcnt lgkmcnt(13)
    ds_read_b64_tr_b16 v[134:135], v147 offset:10624
    s_waitcnt lgkmcnt(0)
    s_waitcnt vmcnt(26)
    v_mfma_f32_16x16x32_bf16 a[0:3], v[100:103], v[16:19], a[0:3]
    s_add_u32 m0, s24, 9216
    s_nop 0
    buffer_load_dwordx4 v138, s[8:11], s30 offen lds
    v_mfma_f32_16x16x32_bf16 a[4:7], v[100:103], v[20:23], a[4:7]
    s_add_u32 m0, s24, 10240
    s_nop 0
    buffer_load_dwordx4 v139, s[8:11], s30 offen lds
    v_mfma_f32_16x16x32_bf16 a[8:11], v[100:103], v[24:27], a[8:11]
    s_add_u32 m0, s24, 11264
    s_nop 0
    buffer_load_dwordx4 v140, s[8:11], s30 offen lds
    v_mfma_f32_16x16x32_bf16 a[12:15], v[100:103], v[28:31], a[12:15]
    v_mfma_f32_16x16x32_bf16 a[16:19], v[104:107], v[16:19], a[16:19]
    s_add_u32 m0, s24, 12288
    s_nop 0
    buffer_load_dwordx4 v141, s[8:11], s30 offen lds
    v_mfma_f32_16x16x32_bf16 a[20:23], v[104:107], v[20:23], a[20:23]
    s_add_u32 m0, s24, 13312
    s_nop 0
    buffer_load_dwordx4 v142, s[8:11], s30 offen lds
    v_mfma_f32_16x16x32_bf16 a[24:27], v[104:107], v[24:27], a[24:27]
    s_add_u32 m0, s24, 14336
    s_nop 0
    buffer_load_dwordx4 v143, s[8:11], s30 offen lds
    v_mfma_f32_16x16x32_bf16 a[28:31], v[104:107], v[28:31], a[28:31]
    s_add_u32 m0, s24, 15360
    s_nop 0
    buffer_load_dwordx4 v144, s[8:11], s30 offen lds
    v_mfma_f32_16x16x32_bf16 a[32:35], v[108:111], v[16:19], a[32:35]
    s_add_u32 m0, s24, 16384
    s_nop 0
    buffer_load_dwordx4 v145, s[8:11], s30 offen lds
    v_mfma_f32_16x16x32_bf16 a[36:39], v[108:111], v[20:23], a[36:39]
    s_add_u32 m0, s24, 17408
    s_nop 0
    buffer_load_dwordx4 v146, s[8:11], s30 offen lds
    v_mfma_f32_16x16x32_bf16 a[40:43], v[108:111], v[24:27], a[40:43]
    s_add_u32 s30, s30, 9216
    v_mfma_f32_16x16x32_bf16 a[44:47], v[108:111], v[28:31], a[44:47]
    buffer_load_dwordx4 v[0:3], v136, s[4:7], s31 offen
    v_mfma_f32_16x16x32_bf16 a[48:51], v[112:115], v[16:19], a[48:51]
    buffer_load_dwordx4 v[4:7], v136, s[4:7], s31 offen offset:256
    v_mfma_f32_16x16x32_bf16 a[52:55], v[112:115], v[20:23], a[52:55]
    buffer_load_dwordx4 v[8:11], v137, s[4:7], s31 offen
    v_mfma_f32_16x16x32_bf16 a[56:59], v[112:115], v[24:27], a[56:59]
    buffer_load_dwordx4 v[12:15], v137, s[4:7], s31 offen offset:256
    v_mfma_f32_16x16x32_bf16 a[60:63], v[112:115], v[28:31], a[60:63]
    s_add_u32 s31, s31, 2048
    ds_read_b64_tr_b16 v[64:65], v147 offset:18432
    v_mfma_f32_16x16x32_bf16 a[64:67], v[116:119], v[16:19], a[64:67]
    v_mfma_f32_16x16x32_bf16 a[68:71], v[116:119], v[20:23], a[68:71]
    ds_read_b64_tr_b16 v[66:67], v147 offset:19584
    v_mfma_f32_16x16x32_bf16 a[72:75], v[116:119], v[24:27], a[72:75]
    ds_read_b64_tr_b16 v[68:69], v147 offset:18464
    v_mfma_f32_16x16x32_bf16 a[76:79], v[116:119], v[28:31], a[76:79]
    ds_read_b64_tr_b16 v[70:71], v147 offset:19616
    v_mfma_f32_16x16x32_bf16 a[80:83], v[120:123], v[16:19], a[80:83]
    ds_read_b64_tr_b16 v[72:73], v147 offset:18496
    v_mfma_f32_16x16x32_bf16 a[84:87], v[120:123], v[20:23], a[84:87]
    ds_read_b64_tr_b16 v[74:75], v147 offset:19648
    v_mfma_f32_16x16x32_bf16 a[88:91], v[120:123], v[24:27], a[88:91]
    ds_read_b64_tr_b16 v[76:77], v147 offset:18528
    v_mfma_f32_16x16x32_bf16 a[92:95], v[120:123], v[28:31], a[92:95]
    ds_read_b64_tr_b16 v[78:79], v147 offset:19680
    v_mfma_f32_16x16x32_bf16 a[96:99], v[124:127], v[16:19], a[96:99]
    v_mfma_f32_16x16x32_bf16 a[100:103], v[124:127], v[20:23], a[100:103]
    ds_read_b64_tr_b16 v[80:81], v147 offset:18560
    v_mfma_f32_16x16x32_bf16 a[104:107], v[124:127], v[24:27], a[104:107]
    ds_read_b64_tr_b16 v[82:83], v147 offset:19712
    v_mfma_f32_16x16x32_bf16 a[108:111], v[124:127], v[28:31], a[108:111]
    ds_read_b64_tr_b16 v[84:85], v147 offset:18592
    v_mfma_f32_16x16x32_bf16 a[112:115], v[128:131], v[16:19], a[112:115]
    ds_read_b64_tr_b16 v[86:87], v147 offset:19744
    v_mfma_f32_16x16x32_bf16 a[116:119], v[128:131], v[20:23], a[116:119]
    ds_read_b64_tr_b16 v[88:89], v147 offset:18624
    v_mfma_f32_16x16x32_bf16 a[120:123], v[128:131], v[24:27], a[120:123]
    ds_read_b64_tr_b16 v[90:91], v147 offset:19776
    v_mfma_f32_16x16x32_bf16 a[124:127], v[128:131], v[28:31], a[124:127]
    ds_read_b64_tr_b16 v[92:93], v147 offset:18656
    v_mfma_f32_16x16x32_bf16 a[128:131], v[132:135], v[16:19], a[128:131]
    v_mfma_f32_16x16x32_bf16 a[132:135], v[132:135], v[20:23], a[132:135]
    s_waitcnt lgkmcnt(13)
    ds_read_b64_tr_b16 v[94:95], v147 offset:19808
    v_mfma_f32_16x16x32_bf16 a[136:139], v[132:135], v[24:27], a[136:139]
    ds_read_b64_tr_b16 v[96:97], v147 offset:18688
    v_mfma_f32_16x16x32_bf16 a[140:143], v[132:135], v[28:31], a[140:143]
    s_waitcnt lgkmcnt(13)
    ds_read_b64_tr_b16 v[98:99], v147 offset:19840
    s_waitcnt lgkmcnt(0)
    s_waitcnt vmcnt(26)
    v_mfma_f32_16x16x32_bf16 a[0:3], v[64:67], v[32:35], a[0:3]
    s_add_u32 m0, s24, 18432
    s_nop 0
    buffer_load_dwordx4 v138, s[8:11], s30 offen lds
    v_mfma_f32_16x16x32_bf16 a[4:7], v[64:67], v[36:39], a[4:7]
    s_add_u32 m0, s24, 19456
    s_nop 0
    buffer_load_dwordx4 v139, s[8:11], s30 offen lds
    v_mfma_f32_16x16x32_bf16 a[8:11], v[64:67], v[40:43], a[8:11]
    s_add_u32 m0, s24, 20480
    s_nop 0
    buffer_load_dwordx4 v140, s[8:11], s30 offen lds
    v_mfma_f32_16x16x32_bf16 a[12:15], v[64:67], v[44:47], a[12:15]
    v_mfma_f32_16x16x32_bf16 a[16:19], v[68:71], v[32:35], a[16:19]
    s_add_u32 m0, s24, 21504
    s_nop 0
    buffer_load_dwordx4 v141, s[8:11], s30 offen lds
    v_mfma_f32_16x16x32_bf16 a[20:23], v[68:71], v[36:39], a[20:23]
    s_add_u32 m0, s24, 22528
    s_nop 0
    buffer_load_dwordx4 v142, s[8:11], s30 offen lds
    v_mfma_f32_16x16x32_bf16 a[24:27], v[68:71], v[40:43], a[24:27]
    s_add_u32 m0, s24, 23552
    s_nop 0
    buffer_load_dwordx4 v143, s[8:11], s30 offen lds
    v_mfma_f32_16x16x32_bf16 a[28:31], v[68:71], v[44:47], a[28:31]
    s_add_u32 m0, s24, 24576
    s_nop 0
    buffer_load_dwordx4 v144, s[8:11], s30 offen lds
    v_mfma_f32_16x16x32_bf16 a[32:35], v[72:75], v[32:35], a[32:35]
    s_add_u32 m0, s24, 25600
    s_nop 0
    buffer_load_dwordx4 v145, s[8:11], s30 offen lds
    v_mfma_f32_16x16x32_bf16 a[36:39], v[72:75], v[36:39], a[36:39]
    s_add_u32 m0, s24, 26624
    s_nop 0
    buffer_load_dwordx4 v146, s[8:11], s30 offen lds
    v_mfma_f32_16x16x32_bf16 a[40:43], v[72:75], v[40:43], a[40:43]
    s_add_u32 s30, s30, 9216
    v_mfma_f32_16x16x32_bf16 a[44:47], v[72:75], v[44:47], a[44:47]
    buffer_load_dwordx4 v[16:19], v136, s[4:7], s31 offen
    v_mfma_f32_16x16x32_bf16 a[48:51], v[76:79], v[32:35], a[48:51]
    buffer_load_dwordx4 v[20:23], v136, s[4:7], s31 offen offset:256
    v_mfma_f32_16x16x32_bf16 a[52:55], v[76:79], v[36:39], a[52:55]
    buffer_load_dwordx4 v[24:27], v137, s[4:7], s31 offen
    v_mfma_f32_16x16x32_bf16 a[56:59], v[76:79], v[40:43], a[56:59]
    buffer_load_dwordx4 v[28:31], v137, s[4:7], s31 offen offset:256
    v_mfma_f32_16x16x32_bf16 a[60:63], v[76:79], v[44:47], a[60:63]
    s_add_u32 s31, s31, 2048
    ds_read_b64_tr_b16 v[100:101], v147 offset:27648
    v_mfma_f32_16x16x32_bf16 a[64:67], v[80:83], v[32:35], a[64:67]
    v_mfma_f32_16x16x32_bf16 a[68:71], v[80:83], v[36:39], a[68:71]
    ds_read_b64_tr_b16 v[102:103], v147 offset:28800
    v_mfma_f32_16x16x32_bf16 a[72:75], v[80:83], v[40:43], a[72:75]
    ds_read_b64_tr_b16 v[104:105], v147 offset:27680
    v_mfma_f32_16x16x32_bf16 a[76:79], v[80:83], v[44:47], a[76:79]
    ds_read_b64_tr_b16 v[106:107], v147 offset:28832
    v_mfma_f32_16x16x32_bf16 a[80:83], v[84:87], v[32:35], a[80:83]
    ds_read_b64_tr_b16 v[108:109], v147 offset:27712
    v_mfma_f32_16x16x32_bf16 a[84:87], v[84:87], v[36:39], a[84:87]
    ds_read_b64_tr_b16 v[110:111], v147 offset:28864
    v_mfma_f32_16x16x32_bf16 a[88:91], v[84:87], v[40:43], a[88:91]
    ds_read_b64_tr_b16 v[112:113], v147 offset:27744
    v_mfma_f32_16x16x32_bf16 a[92:95], v[84:87], v[44:47], a[92:95]
    ds_read_b64_tr_b16 v[114:115], v147 offset:28896
    v_mfma_f32_16x16x32_bf16 a[96:99], v[88:91], v[32:35], a[96:99]
    v_mfma_f32_16x16x32_bf16 a[100:103], v[88:91], v[36:39], a[100:103]
    ds_read_b64_tr_b16 v[116:117], v147 offset:27776
    v_mfma_f32_16x16x32_bf16 a[104:107], v[88:91], v[40:43], a[104:107]
    ds_read_b64_tr_b16 v[118:119], v147 offset:28928
    v_mfma_f32_16x16x32_bf16 a[108:111], v[88:91], v[44:47], a[108:111]
    ds_read_b64_tr_b16 v[120:121], v147 offset:27808
    v_mfma_f32_16x16x32_bf16 a[112:115], v[92:95], v[32:35], a[112:115]
    ds_read_b64_tr_b16 v[122:123], v147 offset:28960
    v_mfma_f32_16x16x32_bf16 a[116:119], v[92:95], v[36:39], a[116:119]
    ds_read_b64_tr_b16 v[124:125], v147 offset:27840
    v_mfma_f32_16x16x32_bf16 a[120:123], v[92:95], v[40:43], a[120:123]
    ds_read_b64_tr_b16 v[126:127], v147 offset:28992
    v_mfma_f32_16x16x32_bf16 a[124:127], v[92:95], v[44:47], a[124:127]
    ds_read_b64_tr_b16 v[128:129], v147 offset:27872
    v_mfma_f32_16x16x32_bf16 a[128:131], v[96:99], v[32:35], a[128:131]
    v_mfma_f32_16x16x32_bf16 a[132:135], v[96:99], v[36:39], a[132:135]
    s_waitcnt lgkmcnt(13)
    ds_read_b64_tr_b16 v[130:131], v147 offset:29024
    v_mfma_f32_16x16x32_bf16 a[136:139], v[96:99], v[40:43], a[136:139]
    ds_read_b64_tr_b16 v[132:133], v147 offset:27904
    v_mfma_f32_16x16x32_bf16 a[140:143], v[96:99], v[44:47], a[140:143]
    s_waitcnt lgkmcnt(13)
    ds_read_b64_tr_b16 v[134:135], v147 offset:29056
    s_waitcnt lgkmcnt(0)
    s_waitcnt vmcnt(26)
    v_mfma_f32_16x16x32_bf16 a[0:3], v[100:103], v[48:51], a[0:3]
    s_add_u32 m0, s24, 27648
    s_nop 0
    buffer_load_dwordx4 v138, s[8:11], s30 offen lds
    v_mfma_f32_16x16x32_bf16 a[4:7], v[100:103], v[52:55], a[4:7]
    s_add_u32 m0, s24, 28672
    s_nop 0
    buffer_load_dwordx4 v139, s[8:11], s30 offen lds
    v_mfma_f32_16x16x32_bf16 a[8:11], v[100:103], v[56:59], a[8:11]
    s_add_u32 m0, s24, 29696
    s_nop 0
    buffer_load_dwordx4 v140, s[8:11], s30 offen lds
    v_mfma_f32_16x16x32_bf16 a[12:15], v[100:103], v[60:63], a[12:15]
    v_mfma_f32_16x16x32_bf16 a[16:19], v[104:107], v[48:51], a[16:19]
    s_add_u32 m0, s24, 30720
    s_nop 0
    buffer_load_dwordx4 v141, s[8:11], s30 offen lds
    v_mfma_f32_16x16x32_bf16 a[20:23], v[104:107], v[52:55], a[20:23]
    s_add_u32 m0, s24, 31744
    s_nop 0
    buffer_load_dwordx4 v142, s[8:11], s30 offen lds
    v_mfma_f32_16x16x32_bf16 a[24:27], v[104:107], v[56:59], a[24:27]
    s_add_u32 m0, s24, 32768
    s_nop 0
    buffer_load_dwordx4 v143, s[8:11], s30 offen lds
    v_mfma_f32_16x16x32_bf16 a[28:31], v[104:107], v[60:63], a[28:31]
    s_add_u32 m0, s24, 33792
    s_nop 0
    buffer_load_dwordx4 v144, s[8:11], s30 offen lds
    v_mfma_f32_16x16x32_bf16 a[32:35], v[108:111], v[48:51], a[32:35]
    s_add_u32 m0, s24, 34816
    s_nop 0
    buffer_load_dwordx4 v145, s[8:11], s30 offen lds
    v_mfma_f32_16x16x32_bf16 a[36:39], v[108:111], v[52:55], a[36:39]
    s_add_u32 m0, s24, 35840
    s_nop 0
    buffer_load_dwordx4 v146, s[8:11], s30 offen lds
    v_mfma_f32_16x16x32_bf16 a[40:43], v[108:111], v[56:59], a[40:43]
    s_add_u32 s30, s30, 9216
    v_mfma_f32_16x16x32_bf16 a[44:47], v[108:111], v[60:63], a[44:47]
    buffer_load_dwordx4 v[32:35], v136, s[4:7], s31 offen
    v_mfma_f32_16x16x32_bf16 a[48:51], v[112:115], v[48:51], a[48:51]
    buffer_load_dwordx4 v[36:39], v136, s[4:7], s31 offen offset:256
    v_mfma_f32_16x16x32_bf16 a[52:55], v[112:115], v[52:55], a[52:55]
    buffer_load_dwordx4 v[40:43], v137, s[4:7], s31 offen
    v_mfma_f32_16x16x32_bf16 a[56:59], v[112:115], v[56:59], a[56:59]
    buffer_load_dwordx4 v[44:47], v137, s[4:7], s31 offen offset:256
    v_mfma_f32_16x16x32_bf16 a[60:63], v[112:115], v[60:63], a[60:63]
    s_add_u32 s31, s31, 2048
    ds_read_b64_tr_b16 v[64:65], v147 offset:0
    v_mfma_f32_16x16x32_bf16 a[64:67], v[116:119], v[48:51], a[64:67]
    v_mfma_f32_16x16x32_bf16 a[68:71], v[116:119], v[52:55], a[68:71]
    ds_read_b64_tr_b16 v[66:67], v147 offset:1152
    v_mfma_f32_16x16x32_bf16 a[72:75], v[116:119], v[56:59], a[72:75]
    ds_read_b64_tr_b16 v[68:69], v147 offset:32
    v_mfma_f32_16x16x32_bf16 a[76:79], v[116:119], v[60:63], a[76:79]
    ds_read_b64_tr_b16 v[70:71], v147 offset:1184
    v_mfma_f32_16x16x32_bf16 a[80:83], v[120:123], v[48:51], a[80:83]
    ds_read_b64_tr_b16 v[72:73], v147 offset:64
    v_mfma_f32_16x16x32_bf16 a[84:87], v[120:123], v[52:55], a[84:87]
    ds_read_b64_tr_b16 v[74:75], v147 offset:1216
    v_mfma_f32_16x16x32_bf16 a[88:91], v[120:123], v[56:59], a[88:91]
    ds_read_b64_tr_b16 v[76:77], v147 offset:96
    v_mfma_f32_16x16x32_bf16 a[92:95], v[120:123], v[60:63], a[92:95]
    ds_read_b64_tr_b16 v[78:79], v147 offset:1248
    v_mfma_f32_16x16x32_bf16 a[96:99], v[124:127], v[48:51], a[96:99]
    v_mfma_f32_16x16x32_bf16 a[100:103], v[124:127], v[52:55], a[100:103]
    ds_read_b64_tr_b16 v[80:81], v147 offset:128
    v_mfma_f32_16x16x32_bf16 a[104:107], v[124:127], v[56:59], a[104:107]
    ds_read_b64_tr_b16 v[82:83], v147 offset:1280
    v_mfma_f32_16x16x32_bf16 a[108:111], v[124:127], v[60:63], a[108:111]
    ds_read_b64_tr_b16 v[84:85], v147 offset:160
    v_mfma_f32_16x16x32_bf16 a[112:115], v[128:131], v[48:51], a[112:115]
    ds_read_b64_tr_b16 v[86:87], v147 offset:1312
    v_mfma_f32_16x16x32_bf16 a[116:119], v[128:131], v[52:55], a[116:119]
    ds_read_b64_tr_b16 v[88:89], v147 offset:192
    v_mfma_f32_16x16x32_bf16 a[120:123], v[128:131], v[56:59], a[120:123]
    ds_read_b64_tr_b16 v[90:91], v147 offset:1344
    v_mfma_f32_16x16x32_bf16 a[124:127], v[128:131], v[60:63], a[124:127]
    ds_read_b64_tr_b16 v[92:93], v147 offset:224
    v_mfma_f32_16x16x32_bf16 a[128:131], v[132:135], v[48:51], a[128:131]
    v_mfma_f32_16x16x32_bf16 a[132:135], v[132:135], v[52:55], a[132:135]
    s_waitcnt lgkmcnt(13)
    ds_read_b64_tr_b16 v[94:95], v147 offset:1376
    v_mfma_f32_16x16x32_bf16 a[136:139], v[132:135], v[56:59], a[136:139]
    ds_read_b64_tr_b16 v[96:97], v147 offset:256
    v_mfma_f32_16x16x32_bf16 a[140:143], v[132:135], v[60:63], a[140:143]
    s_waitcnt lgkmcnt(13)
    ds_read_b64_tr_b16 v[98:99], v147 offset:1408
    s_mov_b32 s27, 6
L2_loop:
    s_waitcnt lgkmcnt(0)
    s_waitcnt vmcnt(26)
    v_mfma_f32_16x16x32_bf16 a[0:3], v[64:67], v[0:3], a[0:3]
    s_add_u32 m0, s24, 0
    s_nop 0
    buffer_load_dwordx4 v138, s[8:11], s30 offen lds
    v_mfma_f32_16x16x32_bf16 a[4:7], v[64:67], v[4:7], a[4:7]
    s_add_u32 m0, s24, 1024
    s_nop 0
    buffer_load_dwordx4 v139, s[8:11], s30 offen lds
    v_mfma_f32_16x16x32_bf16 a[8:11], v[64:67], v[8:11], a[8:11]
    s_add_u32 m0, s24, 2048
    s_nop 0
    buffer_load_dwordx4 v140, s[8:11], s30 offen lds
    v_mfma_f32_16x16x32_bf16 a[12:15], v[64:67], v[12:15], a[12:15]
    v_mfma_f32_16x16x32_bf16 a[16:19], v[68:71], v[0:3], a[16:19]
    s_add_u32 m0, s24, 3072
    s_nop 0
    buffer_load_dwordx4 v141, s[8:11], s30 offen lds
    v_mfma_f32_16x16x32_bf16 a[20:23], v[68:71], v[4:7], a[20:23]
    s_add_u32 m0, s24, 4096
    s_nop 0
    buffer_load_dwordx4 v142, s[8:11], s30 offen lds
    v_mfma_f32_16x16x32_bf16 a[24:27], v[68:71], v[8:11], a[24:27]
    s_add_u32 m0, s24, 5120
    s_nop 0
    buffer_load_dwordx4 v143, s[8:11], s30 offen lds
    v_mfma_f32_16x16x32_bf16 a[28:31], v[68:71], v[12:15], a[28:31]
    s_add_u32 m0, s24, 6144
    s_nop 0
    buffer_load_dwordx4 v144, s[8:11], s30 offen lds
    v_mfma_f32_16x16x32_bf16 a[32:35], v[72:75], v[0:3], a[32:35]
    s_add_u32 m0, s24, 7168
    s_nop 0
    buffer_load_dwordx4 v145, s[8:11], s30 offen lds
    v_mfma_f32_16x16x32_bf16 a[36:39], v[72:75], v[4:7], a[36:39]
    s_add_u32 m0, s24, 8192
    s_nop 0
    buffer_load_dwordx4 v146, s[8:11], s30 offen lds
    v_mfma_f32_16x16x32_bf16 a[40:43], v[72:75], v[8:11], a[40:43]
    s_add_u32 s30, s30, 9216
    v_mfma_f32_16x16x32_bf16 a[44:47], v[72:75], v[12:15], a[44:47]
    buffer_load_dwordx4 v[48:51], v136, s[4:7], s31 offen
    v_mfma_f32_16x16x32_bf16 a[48:51], v[76:79], v[0:3], a[48:51]
    buffer_load_dwordx4 v[52:55], v136, s[4:7], s31 offen offset:256
    v_mfma_f32_16x16x32_bf16 a[52:55], v[76:79], v[4:7], a[52:55]
    buffer_load_dwordx4 v[56:59], v137, s[4:7], s31 offen
    v_mfma_f32_16x16x32_bf16 a[56:59], v[76:79], v[8:11], a[56:59]
    buffer_load_dwordx4 v[60:63], v137, s[4:7], s31 offen offset:256
    v_mfma_f32_16x16x32_bf16 a[60:63], v[76:79], v[12:15], a[60:63]
    s_add_u32 s31, s31, 2048
    ds_read_b64_tr_b16 v[100:101], v147 offset:9216
    v_mfma_f32_16x16x32_bf16 a[64:67], v[80:83], v[0:3], a[64:67]
    v_mfma_f32_16x16x32_bf16 a[68:71], v[80:83], v[4:7], a[68:71]
    ds_read_b64_tr_b16 v[102:103], v147 offset:10368
    v_mfma_f32_16x16x32_bf16 a[72:75], v[80:83], v[8:11], a[72:75]
    ds_read_b64_tr_b16 v[104:105], v147 offset:9248
    v_mfma_f32_16x16x32_bf16 a[76:79], v[80:83], v[12:15], a[76:79]
    ds_read_b64_tr_b16 v[106:107], v147 offset:10400
    v_mfma_f32_16x16x32_bf16 a[80:83], v[84:87], v[0:3], a[80:83]
    ds_read_b64_tr_b16 v[108:109], v147 offset:9280
    v_mfma_f32_16x16x32_bf16 a[84:87], v[84:87], v[4:7], a[84:87]
    ds_read_b64_tr_b16 v[110:111], v147 offset:10432
    v_mfma_f32_16x16x32_bf16 a[88:91], v[84:87], v[8:11], a[88:91]
    ds_read_b64_tr_b16 v[112:113], v147 offset:9312
    v_mfma_f32_16x16x32_bf16 a[92:95], v[84:87], v[12:15], a[92:95]
    ds_read_b64_tr_b16 v[114:115], v147 offset:10464
    v_mfma_f32_16x16x32_bf16 a[96:99], v[88:91], v[0:3], a[96:99]
    v_mfma_f32_16x16x32_bf16 a[100:103], v[88:91], v[4:7], a[100:103]
    ds_read_b64_tr_b16 v[116:117], v147 offset:9344
    v_mfma_f32_16x16x32_bf16 a[104:107], v[88:91], v[8:11], a[104:107]
    ds_read_b64_tr_b16 v[118:119], v147 offset:10496
    v_mfma_f32_16x16x32_bf16 a[108:111], v[88:91], v[12:15], a[108:111]
    ds_read_b64_tr_b16 v[120:121], v147 offset:9376
    v_mfma_f32_16x16x32_bf16 a[112:115], v[92:95], v[0:3], a[112:115]
    ds_read_b64_tr_b16 v[122:123], v147 offset:10528
    v_mfma_f32_16x16x32_bf16 a[116:119], v[92:95], v[4:7], a[116:119]
    ds_read_b64_tr_b16 v[124:125], v147 offset:9408
    v_mfma_f32_16x16x32_bf16 a[120:123], v[92:95], v[8:11], a[120:123]
    ds_read_b64_tr_b16 v[126:127], v147 offset:10560
    v_mfma_f32_16x16x32_bf16 a[124:127], v[92:95], v[12:15], a[124:127]
    ds_read_b64_tr_b16 v[128:129], v147 offset:9440
    v_mfma_f32_16x16x32_bf16 a[128:131], v[96:99], v[0:3], a[128:131]
    v_mfma_f32_16x16x32_bf16 a[132:135], v[96:99], v[4:7], a[132:135]
    s_waitcnt lgkmcnt(13)
    ds_read_b64_tr_b16 v[130:131], v147 offset:10592
    v_mfma_f32_16x16x32_bf16 a[136:139], v[96:99], v[8:11], a[136:139]
    ds_read_b64_tr_b16 v[132:133], v147 offset:9472
    v_mfma_f32_16x16x32_bf16 a[140:143], v[96:99], v[12:15], a[140:143]
    s_waitcnt lgkmcnt(13)
    ds_read_b64_tr_b16 v[134:135], v147 offset:10624
    s_waitcnt lgkmcnt(0)
    s_waitcnt vmcnt(26)
    v_mfma_f32_16x16x32_bf16 a[0:3], v[100:103], v[16:19], a[0:3]
    s_add_u32 m0, s24, 9216
    s_nop 0
    buffer_load_dwordx4 v138, s[8:11], s30 offen lds
    v_mfma_f32_16x16x32_bf16 a[4:7], v[100:103], v[20:23], a[4:7]
    s_add_u32 m0, s24, 10240
    s_nop 0
    buffer_load_dwordx4 v139, s[8:11], s30 offen lds
    v_mfma_f32_16x16x32_bf16 a[8:11], v[100:103], v[24:27], a[8:11]
    s_add_u32 m0, s24, 11264
    s_nop 0
    buffer_load_dwordx4 v140, s[8:11], s30 offen lds
    v_mfma_f32_16x16x32_bf16 a[12:15], v[100:103], v[28:31], a[12:15]
    v_mfma_f32_16x16x32_bf16 a[16:19], v[104:107], v[16:19], a[16:19]
    s_add_u32 m0, s24, 12288
    s_nop 0
    buffer_load_dwordx4 v141, s[8:11], s30 offen lds
    v_mfma_f32_16x16x32_bf16 a[20:23], v[104:107], v[20:23], a[20:23]
    s_add_u32 m0, s24, 13312
    s_nop 0
    buffer_load_dwordx4 v142, s[8:11], s30 offen lds
    v_mfma_f32_16x16x32_bf16 a[24:27], v[104:107], v[24:27], a[24:27]
    s_add_u32 m0, s24, 14336
    s_nop 0
    buffer_load_dwordx4 v143, s[8:11], s30 offen lds
    v_mfma_f32_16x16x32_bf16 a[28:31], v[104:107], v[28:31], a[28:31]
    s_add_u32 m0, s24, 15360
    s_nop 0
    buffer_load_dwordx4 v144, s[8:11], s30 offen lds
    v_mfma_f32_16x16x32_bf16 a[32:35], v[108:111], v[16:19], a[32:35]
    s_add_u32 m0, s24, 16384
    s_nop 0
    buffer_load_dwordx4 v145, s[8:11], s30 offen lds
    v_mfma_f32_16x16x32_bf16 a[36:39], v[108:111], v[20:23], a[36:39]
    s_add_u32 m0, s24, 17408
    s_nop 0
    buffer_load_dwordx4 v146, s[8:11], s30 offen lds
    v_mfma_f32_16x16x32_bf16 a[40:43], v[108:111], v[24:27], a[40:43]
    s_add_u32 s30, s30, 9216
    v_mfma_f32_16x16x32_bf16 a[44:47], v[108:111], v[28:31], a[44:47]
    buffer_load_dwordx4 v[0:3], v136, s[4:7], s31 offen
    v_mfma_f32_16x16x32_bf16 a[48:51], v[112:115], v[16:19], a[48:51]
    buffer_load_dwordx4 v[4:7], v136, s[4:7], s31 offen offset:256
    v_mfma_f32_16x16x32_bf16 a[52:55], v[112:115], v[20:23], a[52:55]
    buffer_load_dwordx4 v[8:11], v137, s[4:7], s31 offen
    v_mfma_f32_16x16x32_bf16 a[56:59], v[112:115], v[24:27], a[56:59]
    buffer_load_dwordx4 v[12:15], v137, s[4:7], s31 offen offset:256
    v_mfma_f32_16x16x32_bf16 a[60:63], v[112:115], v[28:31], a[60:63]
    s_add_u32 s31, s31, 2048
    ds_read_b64_tr_b16 v[64:65], v147 offset:18432
    v_mfma_f32_16x16x32_bf16 a[64:67], v[116:119], v[16:19], a[64:67]
    v_mfma_f32_16x16x32_bf16 a[68:71], v[116:119], v[20:23], a[68:71]
    ds_read_b64_tr_b16 v[66:67], v147 offset:19584
    v_mfma_f32_16x16x32_bf16 a[72:75], v[116:119], v[24:27], a[72:75]
    ds_read_b64_tr_b16 v[68:69], v147 offset:18464
    v_mfma_f32_16x16x32_bf16 a[76:79], v[116:119], v[28:31], a[76:79]
    ds_read_b64_tr_b16 v[70:71], v147 offset:19616
    v_mfma_f32_16x16x32_bf16 a[80:83], v[120:123], v[16:19], a[80:83]
    ds_read_b64_tr_b16 v[72:73], v147 offset:18496
    v_mfma_f32_16x16x32_bf16 a[84:87], v[120:123], v[20:23], a[84:87]
    ds_read_b64_tr_b16 v[74:75], v147 offset:19648
    v_mfma_f32_16x16x32_bf16 a[88:91], v[120:123], v[24:27], a[88:91]
    ds_read_b64_tr_b16 v[76:77], v147 offset:18528
    v_mfma_f32_16x16x32_bf16 a[92:95], v[120:123], v[28:31], a[92:95]
    ds_read_b64_tr_b16 v[78:79], v147 offset:19680
    v_mfma_f32_16x16x32_bf16 a[96:99], v[124:127], v[16:19], a[96:99]
    v_mfma_f32_16x16x32_bf16 a[100:103], v[124:127], v[20:23], a[100:103]
    ds_read_b64_tr_b16 v[80:81], v147 offset:18560
    v_mfma_f32_16x16x32_bf16 a[104:107], v[124:127], v[24:27], a[104:107]
    ds_read_b64_tr_b16 v[82:83], v147 offset:19712
    v_mfma_f32_16x16x32_bf16 a[108:111], v[124:127], v[28:31], a[108:111]
    ds_read_b64_tr_b16 v[84:85], v147 offset:18592
    v_mfma_f32_16x16x32_bf16 a[112:115], v[128:131], v[16:19], a[112:115]
    ds_read_b64_tr_b16 v[86:87], v147 offset:19744
    v_mfma_f32_16x16x32_bf16 a[116:119], v[128:131], v[20:23], a[116:119]
    ds_read_b64_tr_b16 v[88:89], v147 offset:18624
    v_mfma_f32_16x16x32_bf16 a[120:123], v[128:131], v[24:27], a[120:123]
    ds_read_b64_tr_b16 v[90:91], v147 offset:19776
    v_mfma_f32_16x16x32_bf16 a[124:127], v[128:131], v[28:31], a[124:127]
    ds_read_b64_tr_b16 v[92:93], v147 offset:18656
    v_mfma_f32_16x16x32_bf16 a[128:131], v[132:135], v[16:19], a[128:131]
    v_mfma_f32_16x16x32_bf16 a[132:135], v[132:135], v[20:23], a[132:135]
    s_waitcnt lgkmcnt(13)
    ds_read_b64_tr_b16 v[94:95], v147 offset:19808
    v_mfma_f32_16x16x32_bf16 a[136:139], v[132:135], v[24:27], a[136:139]
    ds_read_b64_tr_b16 v[96:97], v147 offset:18688
    v_mfma_f32_16x16x32_bf16 a[140:143], v[132:135], v[28:31], a[140:143]
    s_waitcnt lgkmcnt(13)
    ds_read_b64_tr_b16 v[98:99], v147 offset:19840
    s_waitcnt lgkmcnt(0)
    s_waitcnt vmcnt(26)
    v_mfma_f32_16x16x32_bf16 a[0:3], v[64:67], v[32:35], a[0:3]
    s_add_u32 m0, s24, 18432
    s_nop 0
    buffer_load_dwordx4 v138, s[8:11], s30 offen lds
    v_mfma_f32_16x16x32_bf16 a[4:7], v[64:67], v[36:39], a[4:7]
    s_add_u32 m0, s24, 19456
    s_nop 0
    buffer_load_dwordx4 v139, s[8:11], s30 offen lds
    v_mfma_f32_16x16x32_bf16 a[8:11], v[64:67], v[40:43], a[8:11]
    s_add_u32 m0, s24, 20480
    s_nop 0
    buffer_load_dwordx4 v140, s[8:11], s30 offen lds
    v_mfma_f32_16x16x32_bf16 a[12:15], v[64:67], v[44:47], a[12:15]
    v_mfma_f32_16x16x32_bf16 a[16:19], v[68:71], v[32:35], a[16:19]
    s_add_u32 m0, s24, 21504
    s_nop 0
    buffer_load_dwordx4 v141, s[8:11], s30 offen lds
    v_mfma_f32_16x16x32_bf16 a[20:23], v[68:71], v[36:39], a[20:23]
    s_add_u32 m0, s24, 22528
    s_nop 0
    buffer_load_dwordx4 v142, s[8:11], s30 offen lds
    v_mfma_f32_16x16x32_bf16 a[24:27], v[68:71], v[40:43], a[24:27]
    s_add_u32 m0, s24, 23552
    s_nop 0
    buffer_load_dwordx4 v143, s[8:11], s30 offen lds
    v_mfma_f32_16x16x32_bf16 a[28:31], v[68:71], v[44:47], a[28:31]
    s_add_u32 m0, s24, 24576
    s_nop 0
    buffer_load_dwordx4 v144, s[8:11], s30 offen lds
    v_mfma_f32_16x16x32_bf16 a[32:35], v[72:75], v[32:35], a[32:35]
    s_add_u32 m0, s24, 25600
    s_nop 0
    buffer_load_dwordx4 v145, s[8:11], s30 offen lds
    v_mfma_f32_16x16x32_bf16 a[36:39], v[72:75], v[36:39], a[36:39]
    s_add_u32 m0, s24, 26624
    s_nop 0
    buffer_load_dwordx4 v146, s[8:11], s30 offen lds
    v_mfma_f32_16x16x32_bf16 a[40:43], v[72:75], v[40:43], a[40:43]
    s_add_u32 s30, s30, 9216
    v_mfma_f32_16x16x32_bf16 a[44:47], v[72:75], v[44:47], a[44:47]
    buffer_load_dwordx4 v[16:19], v136, s[4:7], s31 offen
    v_mfma_f32_16x16x32_bf16 a[48:51], v[76:79], v[32:35], a[48:51]
    buffer_load_dwordx4 v[20:23], v136, s[4:7], s31 offen offset:256
    v_mfma_f32_16x16x32_bf16 a[52:55], v[76:79], v[36:39], a[52:55]
    buffer_load_dwordx4 v[24:27], v137, s[4:7], s31 offen
    v_mfma_f32_16x16x32_bf16 a[56:59], v[76:79], v[40:43], a[56:59]
    buffer_load_dwordx4 v[28:31], v137, s[4:7], s31 offen offset:256
    v_mfma_f32_16x16x32_bf16 a[60:63], v[76:79], v[44:47], a[60:63]
    s_add_u32 s31, s31, 2048
    ds_read_b64_tr_b16 v[100:101], v147 offset:27648
    v_mfma_f32_16x16x32_bf16 a[64:67], v[80:83], v[32:35], a[64:67]
    v_mfma_f32_16x16x32_bf16 a[68:71], v[80:83], v[36:39], a[68:71]
    ds_read_b64_tr_b16 v[102:103], v147 offset:28800
    v_mfma_f32_16x16x32_bf16 a[72:75], v[80:83], v[40:43], a[72:75]
    ds_read_b64_tr_b16 v[104:105], v147 offset:27680
    v_mfma_f32_16x16x32_bf16 a[76:79], v[80:83], v[44:47], a[76:79]
    ds_read_b64_tr_b16 v[106:107], v147 offset:28832
    v_mfma_f32_16x16x32_bf16 a[80:83], v[84:87], v[32:35], a[80:83]
    ds_read_b64_tr_b16 v[108:109], v147 offset:27712
    v_mfma_f32_16x16x32_bf16 a[84:87], v[84:87], v[36:39], a[84:87]
    ds_read_b64_tr_b16 v[110:111], v147 offset:28864
    v_mfma_f32_16x16x32_bf16 a[88:91], v[84:87], v[40:43], a[88:91]
    ds_read_b64_tr_b16 v[112:113], v147 offset:27744
    v_mfma_f32_16x16x32_bf16 a[92:95], v[84:87], v[44:47], a[92:95]
    ds_read_b64_tr_b16 v[114:115], v147 offset:28896
    v_mfma_f32_16x16x32_bf16 a[96:99], v[88:91], v[32:35], a[96:99]
    v_mfma_f32_16x16x32_bf16 a[100:103], v[88:91], v[36:39], a[100:103]
    ds_read_b64_tr_b16 v[116:117], v147 offset:27776
    v_mfma_f32_16x16x32_bf16 a[104:107], v[88:91], v[40:43], a[104:107]
    ds_read_b64_tr_b16 v[118:119], v147 offset:28928
    v_mfma_f32_16x16x32_bf16 a[108:111], v[88:91], v[44:47], a[108:111]
    ds_read_b64_tr_b16 v[120:121], v147 offset:27808
    v_mfma_f32_16x16x32_bf16 a[112:115], v[92:95], v[32:35], a[112:115]
    ds_read_b64_tr_b16 v[122:123], v147 offset:28960
    v_mfma_f32_16x16x32_bf16 a[116:119], v[92:95], v[36:39], a[116:119]
    ds_read_b64_tr_b16 v[124:125], v147 offset:27840
    v_mfma_f32_16x16x32_bf16 a[120:123], v[92:95], v[40:43], a[120:123]
    ds_read_b64_tr_b16 v[126:127], v147 offset:28992
    v_mfma_f32_16x16x32_bf16 a[124:127], v[92:95], v[44:47], a[124:127]
    ds_read_b64_tr_b16 v[128:129], v147 offset:27872
    v_mfma_f32_16x16x32_bf16 a[128:131], v[96:99], v[32:35], a[128:131]
    v_mfma_f32_16x16x32_bf16 a[132:135], v[96:99], v[36:39], a[132:135]
    s_waitcnt lgkmcnt(13)
    ds_read_b64_tr_b16 v[130:131], v147 offset:29024
    v_mfma_f32_16x16x32_bf16 a[136:139], v[96:99], v[40:43], a[136:139]
    ds_read_b64_tr_b16 v[132:133], v147 offset:27904
    v_mfma_f32_16x16x32_bf16 a[140:143], v[96:99], v[44:47], a[140:143]
    s_waitcnt lgkmcnt(13)
    ds_read_b64_tr_b16 v[134:135], v147 offset:29056
    s_waitcnt lgkmcnt(0)
    s_waitcnt vmcnt(26)
    v_mfma_f32_16x16x32_bf16 a[0:3], v[100:103], v[48:51], a[0:3]
    s_add_u32 m0, s24, 27648
    s_nop 0
    buffer_load_dwordx4 v138, s[8:11], s30 offen lds
    v_mfma_f32_16x16x32_bf16 a[4:7], v[100:103], v[52:55], a[4:7]
    s_add_u32 m0, s24, 28672
    s_nop 0
    buffer_load_dwordx4 v139, s[8:11], s30 offen lds
    v_mfma_f32_16x16x32_bf16 a[8:11], v[100:103], v[56:59], a[8:11]
    s_add_u32 m0, s24, 29696
    s_nop 0
    buffer_load_dwordx4 v140, s[8:11], s30 offen lds
    v_mfma_f32_16x16x32_bf16 a[12:15], v[100:103], v[60:63], a[12:15]
    v_mfma_f32_16x16x32_bf16 a[16:19], v[104:107], v[48:51], a[16:19]
    s_add_u32 m0, s24, 30720
    s_nop 0
    buffer_load_dwordx4 v141, s[8:11], s30 offen lds
    v_mfma_f32_16x16x32_bf16 a[20:23], v[104:107], v[52:55], a[20:23]
    s_add_u32 m0, s24, 31744
    s_nop 0
    buffer_load_dwordx4 v142, s[8:11], s30 offen lds
    v_mfma_f32_16x16x32_bf16 a[24:27], v[104:107], v[56:59], a[24:27]
    s_add_u32 m0, s24, 32768
    s_nop 0
    buffer_load_dwordx4 v143, s[8:11], s30 offen lds
    v_mfma_f32_16x16x32_bf16 a[28:31], v[104:107], v[60:63], a[28:31]
    s_add_u32 m0, s24, 33792
    s_nop 0
    buffer_load_dwordx4 v144, s[8:11], s30 offen lds
    v_mfma_f32_16x16x32_bf16 a[32:35], v[108:111], v[48:51], a[32:35]
    s_add_u32 m0, s24, 34816
    s_nop 0
    buffer_load_dwordx4 v145, s[8:11], s30 offen lds
    v_mfma_f32_16x16x32_bf16 a[36:39], v[108:111], v[52:55], a[36:39]
    s_add_u32 m0, s24, 35840
    s_nop 0
    buffer_load_dwordx4 v146, s[8:11], s30 offen lds
    v_mfma_f32_16x16x32_bf16 a[40:43], v[108:111], v[56:59], a[40:43]
    s_add_u32 s30, s30, 9216
    v_mfma_f32_16x16x32_bf16 a[44:47], v[108:111], v[60:63], a[44:47]
    buffer_load_dwordx4 v[32:35], v136, s[4:7], s31 offen
    v_mfma_f32_16x16x32_bf16 a[48:51], v[112:115], v[48:51], a[48:51]
    buffer_load_dwordx4 v[36:39], v136, s[4:7], s31 offen offset:256
    v_mfma_f32_16x16x32_bf16 a[52:55], v[112:115], v[52:55], a[52:55]
    buffer_load_dwordx4 v[40:43], v137, s[4:7], s31 offen
    v_mfma_f32_16x16x32_bf16 a[56:59], v[112:115], v[56:59], a[56:59]
    buffer_load_dwordx4 v[44:47], v137, s[4:7], s31 offen offset:256
    v_mfma_f32_16x16x32_bf16 a[60:63], v[112:115], v[60:63], a[60:63]
    s_add_u32 s31, s31, 2048
    ds_read_b64_tr_b16 v[64:65], v147 offset:0
    v_mfma_f32_16x16x32_bf16 a[64:67], v[116:119], v[48:51], a[64:67]
    v_mfma_f32_16x16x32_bf16 a[68:71], v[116:119], v[52:55], a[68:71]
    ds_read_b64_tr_b16 v[66:67], v147 offset:1152
    v_mfma_f32_16x16x32_bf16 a[72:75], v[116:119], v[56:59], a[72:75]
    ds_read_b64_tr_b16 v[68:69], v147 offset:32
    v_mfma_f32_16x16x32_bf16 a[76:79], v[116:119], v[60:63], a[76:79]
    ds_read_b64_tr_b16 v[70:71], v147 offset:1184
    v_mfma_f32_16x16x32_bf16 a[80:83], v[120:123], v[48:51], a[80:83]
    ds_read_b64_tr_b16 v[72:73], v147 offset:64
    v_mfma_f32_16x16x32_bf16 a[84:87], v[120:123], v[52:55], a[84:87]
    ds_read_b64_tr_b16 v[74:75], v147 offset:1216
    v_mfma_f32_16x16x32_bf16 a[88:91], v[120:123], v[56:59], a[88:91]
    ds_read_b64_tr_b16 v[76:77], v147 offset:96
    v_mfma_f32_16x16x32_bf16 a[92:95], v[120:123], v[60:63], a[92:95]
    ds_read_b64_tr_b16 v[78:79], v147 offset:1248
    v_mfma_f32_16x16x32_bf16 a[96:99], v[124:127], v[48:51], a[96:99]
    v_mfma_f32_16x16x32_bf16 a[100:103], v[124:127], v[52:55], a[100:103]
    ds_read_b64_tr_b16 v[80:81], v147 offset:128
    v_mfma_f32_16x16x32_bf16 a[104:107], v[124:127], v[56:59], a[104:107]
    ds_read_b64_tr_b16 v[82:83], v147 offset:1280
    v_mfma_f32_16x16x32_bf16 a[108:111], v[124:127], v[60:63], a[108:111]
    ds_read_b64_tr_b16 v[84:85], v147 offset:160
    v_mfma_f32_16x16x32_bf16 a[112:115], v[128:131], v[48:51], a[112:115]
    ds_read_b64_tr_b16 v[86:87], v147 offset:1312
    v_mfma_f32_16x16x32_bf16 a[116:119], v[128:131], v[52:55], a[116:119]
    ds_read_b64_tr_b16 v[88:89], v147 offset:192
    v_mfma_f32_16x16x32_bf16 a[120:123], v[128:131], v[56:59], a[120:123]
    ds_read_b64_tr_b16 v[90:91], v147 offset:1344
    v_mfma_f32_16x16x32_bf16 a[124:127], v[128:131], v[60:63], a[124:127]
    ds_read_b64_tr_b16 v[92:93], v147 offset:224
    v_mfma_f32_16x16x32_bf16 a[128:131], v[132:135], v[48:51], a[128:131]
    v_mfma_f32_16x16x32_bf16 a[132:135], v[132:135], v[52:55], a[132:135]
    s_waitcnt lgkmcnt(13)
    ds_read_b64_tr_b16 v[94:95], v147 offset:1376
    v_mfma_f32_16x16x32_bf16 a[136:139], v[132:135], v[56:59], a[136:139]
    ds_read_b64_tr_b16 v[96:97], v147 offset:256
    v_mfma_f32_16x16x32_bf16 a[140:143], v[132:135], v[60:63], a[140:143]
    s_waitcnt lgkmcnt(13)
    ds_read_b64_tr_b16 v[98:99], v147 offset:1408
    s_sub_u32 s27, s27, 1
    s_cmp_lg_u32 s27, 0
    s_cbranch_scc1 L2_loop
    s_waitcnt lgkmcnt(0)
    s_waitcnt vmcnt(26)
    v_mfma_f32_16x16x32_bf16 a[0:3], v[64:67], v[0:3], a[0:3]
    buffer_load_dwordx4 v[48:51], v136, s[4:7], s31 offen
    v_mfma_f32_16x16x32_bf16 a[4:7], v[64:67], v[4:7], a[4:7]
    v_mfma_f32_16x16x32_bf16 a[8:11], v[64:67], v[8:11], a[8:11]
    buffer_load_dwordx4 v[52:55], v136, s[4:7], s31 offen offset:256
    v_mfma_f32_16x16x32_bf16 a[12:15], v[64:67], v[12:15], a[12:15]
    v_mfma_f32_16x16x32_bf16 a[16:19], v[68:71], v[0:3], a[16:19]
    buffer_load_dwordx4 v[56:59], v137, s[4:7], s31 offen
    v_mfma_f32_16x16x32_bf16 a[20:23], v[68:71], v[4:7], a[20:23]
    buffer_load_dwordx4 v[60:63], v137, s[4:7], s31 offen offset:256
    v_mfma_f32_16x16x32_bf16 a[24:27], v[68:71], v[8:11], a[24:27]
    s_add_u32 s31, s31, 2048
    v_mfma_f32_16x16x32_bf16 a[28:31], v[68:71], v[12:15], a[28:31]
    ds_read_b64_tr_b16 v[100:101], v147 offset:9216
    v_mfma_f32_16x16x32_bf16 a[32:35], v[72:75], v[0:3], a[32:35]
    v_mfma_f32_16x16x32_bf16 a[36:39], v[72:75], v[4:7], a[36:39]
    ds_read_b64_tr_b16 v[102:103], v147 offset:10368
    v_mfma_f32_16x16x32_bf16 a[40:43], v[72:75], v[8:11], a[40:43]
    ds_read_b64_tr_b16 v[104:105], v147 offset:9248
    v_mfma_f32_16x16x32_bf16 a[44:47], v[72:75], v[12:15], a[44:47]
    v_mfma_f32_16x16x32_bf16 a[48:51], v[76:79], v[0:3], a[48:51]
    ds_read_b64_tr_b16 v[106:107], v147 offset:10400
    v_mfma_f32_16x16x32_bf16 a[52:55], v[76:79], v[4:7], a[52:55]
    v_mfma_f32_16x16x32_bf16 a[56:59], v[76:79], v[8:11], a[56:59]
    ds_read_b64_tr_b16 v[108:109], v147 offset:9280
    v_mfma_f32_16x16x32_bf16 a[60:63], v[76:79], v[12:15], a[60:63]
    ds_read_b64_tr_b16 v[110:111], v147 offset:10432
    v_mfma_f32_16x16x32_bf16 a[64:67], v[80:83], v[0:3], a[64:67]
    v_mfma_f32_16x16x32_bf16 a[68:71], v[80:83], v[4:7], a[68:71]
    ds_read_b64_tr_b16 v[112:113], v147 offset:9312
    v_mfma_f32_16x16x32_bf16 a[72:75], v[80:83], v[8:11], a[72:75]
    ds_read_b64_tr_b16 v[114:115], v147 offset:10464
    v_mfma_f32_16x16x32_bf16 a[76:79], v[80:83], v[12:15], a[76:79]
    v_mfma_f32_16x16x32_bf16 a[80:83], v[84:87], v[0:3], a[80:83]
    ds_read_b64_tr_b16 v[116:117], v147 offset:9344
    v_mfma_f32_16x16x32_bf16 a[84:87], v[84:87], v[4:7], a[84:87]
    v_mfma_f32_16x16x32_bf16 a[88:91], v[84:87], v[8:11], a[88:91]
    ds_read_b64_tr_b16 v[118:119], v147 offset:10496
    v_mfma_f32_16x16x32_bf16 a[92:95], v[84:87], v[12:15], a[92:95]
    ds_read_b64_tr_b16 v[120:121], v147 offset:9376
    v_mfma_f32_16x16x32_bf16 a[96:99], v[88:91], v[0:3], a[96:99]
    v_mfma_f32_16x16x32_bf16 a[100:103], v[88:91], v[4:7], a[100:103]
    ds_read_b64_tr_b16 v[122:123], v147 offset:10528
    v_mfma_f32_16x16x32_bf16 a[104:107], v[88:91], v[8:11], a[104:107]
    v_mfma_f32_16x16x32_bf16 a[108:111], v[88:91], v[12:15], a[108:111]
    ds_read_b64_tr_b16 v[124:125], v147 offset:9408
    v_mfma_f32_16x16x32_bf16 a[112:115], v[92:95], v[0:3], a[112:115]
    ds_read_b64_tr_b16 v[126:127], v147 offset:10560
    v_mfma_f32_16x16x32_bf16 a[116:119], v[92:95], v[4:7], a[116:119]
    v_mfma_f32_16x16x32_bf16 a[120:123], v[92:95], v[8:11], a[120:123]
    ds_read_b64_tr_b16 v[128:129], v147 offset:9440
    v_mfma_f32_16x16x32_bf16 a[124:127], v[92:95], v[12:15], a[124:127]
    s_waitcnt lgkmcnt(13)
    ds_read_b64_tr_b16 v[130:131], v147 offset:10592
    v_mfma_f32_16x16x32_bf16 a[128:131], v[96:99], v[0:3], a[128:131]
    v_mfma_f32_16x16x32_bf16 a[132:135], v[96:99], v[4:7], a[132:135]
    ds_read_b64_tr_b16 v[132:133], v147 offset:9472
    v_mfma_f32_16x16x32_bf16 a[136:139], v[96:99], v[8:11], a[136:139]
    v_mfma_f32_16x16x32_bf16 a[140:143], v[96:99], v[12:15], a[140:143]
    s_waitcnt lgkmcnt(13)
    ds_read_b64_tr_b16 v[134:135], v147 offset:10624
    s_waitcnt lgkmcnt(0)
    s_waitcnt vmcnt(17)
    v_mfma_f32_16x16x32_bf16 a[0:3], v[100:103], v[16:19], a[0:3]
    ds_read_b64_tr_b16 v[64:65], v147 offset:18432
    v_mfma_f32_16x16x32_bf16 a[4:7], v[100:103], v[20:23], a[4:7]
    v_mfma_f32_16x16x32_bf16 a[8:11], v[100:103], v[24:27], a[8:11]
    ds_read_b64_tr_b16 v[66:67], v147 offset:19584
    v_mfma_f32_16x16x32_bf16 a[12:15], v[100:103], v[28:31], a[12:15]
    v_mfma_f32_16x16x32_bf16 a[16:19], v[104:107], v[16:19], a[16:19]
    ds_read_b64_tr_b16 v[68:69], v147 offset:18464
    v_mfma_f32_16x16x32_bf16 a[20:23], v[104:107], v[20:23], a[20:23]
    v_mfma_f32_16x16x32_bf16 a[24:27], v[104:107], v[24:27], a[24:27]
    ds_read_b64_tr_b16 v[70:71], v147 offset:19616
    v_mfma_f32_16x16x32_bf16 a[28:31], v[104:107], v[28:31], a[28:31]
    v_mfma_f32_16x16x32_bf16 a[32:35], v[108:111], v[16:19], a[32:35]
    ds_read_b64_tr_b16 v[72:73], v147 offset:18496
    v_mfma_f32_16x16x32_bf16 a[36:39], v[108:111], v[20:23], a[36:39]
    v_mfma_f32_16x16x32_bf16 a[40:43], v[108:111], v[24:27], a[40:43]
    ds_read_b64_tr_b16 v[74:75], v147 offset:19648
    v_mfma_f32_16x16x32_bf16 a[44:47], v[108:111], v[28:31], a[44:47]
    v_mfma_f32_16x16x32_bf16 a[48:51], v[112:115], v[16:19], a[48:51]
    ds_read_b64_tr_b16 v[76:77], v147 offset:18528
    v_mfma_f32_16x16x32_bf16 a[52:55], v[112:115], v[20:23], a[52:55]
    v_mfma_f32_16x16x32_bf16 a[56:59], v[112:115], v[24:27], a[56:59]
    ds_read_b64_tr_b16 v[78:79], v147 offset:19680
    v_mfma_f32_16x16x32_bf16 a[60:63], v[112:115], v[28:31], a[60:63]
    v_mfma_f32_16x16x32_bf16 a[64:67], v[116:119], v[16:19], a[64:67]
    ds_read_b64_tr_b16 v[80:81], v147 offset:18560
    v_mfma_f32_16x16x32_bf16 a[68:71], v[116:119], v[20:23], a[68:71]
    v_mfma_f32_16x16x32_bf16 a[72:75], v[116:119], v[24:27], a[72:75]
    ds_read_b64_tr_b16 v[82:83], v147 offset:19712
    v_mfma_f32_16x16x32_bf16 a[76:79], v[116:119], v[28:31], a[76:79]
    v_mfma_f32_16x16x32_bf16 a[80:83], v[120:123], v[16:19], a[80:83]
    ds_read_b64_tr_b16 v[84:85], v147 offset:18592
    v_mfma_f32_16x16x32_bf16 a[84:87], v[120:123], v[20:23], a[84:87]
    v_mfma_f32_16x16x32_bf16 a[88:91], v[120:123], v[24:27], a[88:91]
    ds_read_b64_tr_b16 v[86:87], v147 offset:19744
    v_mfma_f32_16x16x32_bf16 a[92:95], v[120:123], v[28:31], a[92:95]
    v_mfma_f32_16x16x32_bf16 a[96:99], v[124:127], v[16:19], a[96:99]
    ds_read_b64_tr_b16 v[88:89], v147 offset:18624
    v_mfma_f32_16x16x32_bf16 a[100:103], v[124:127], v[20:23], a[100:103]
    v_mfma_f32_16x16x32_bf16 a[104:107], v[124:127], v[24:27], a[104:107]
    ds_read_b64_tr_b16 v[90:91], v147 offset:19776
    v_mfma_f32_16x16x32_bf16 a[108:111], v[124:127], v[28:31], a[108:111]
    v_mfma_f32_16x16x32_bf16 a[112:115], v[128:131], v[16:19], a[112:115]
    ds_read_b64_tr_b16 v[92:93], v147 offset:18656
    v_mfma_f32_16x16x32_bf16 a[116:119], v[128:131], v[20:23], a[116:119]
    v_mfma_f32_16x16x32_bf16 a[120:123], v[128:131], v[24:27], a[120:123]
    s_waitcnt lgkmcnt(13)
    ds_read_b64_tr_b16 v[94:95], v147 offset:19808
    v_mfma_f32_16x16x32_bf16 a[124:127], v[128:131], v[28:31], a[124:127]
    v_mfma_f32_16x16x32_bf16 a[128:131], v[132:135], v[16:19], a[128:131]
    ds_read_b64_tr_b16 v[96:97], v147 offset:18688
    v_mfma_f32_16x16x32_bf16 a[132:135], v[132:135], v[20:23], a[132:135]
    v_mfma_f32_16x16x32_bf16 a[136:139], v[132:135], v[24:27], a[136:139]
    s_waitcnt lgkmcnt(13)
    ds_read_b64_tr_b16 v[98:99], v147 offset:19840
    v_mfma_f32_16x16x32_bf16 a[140:143], v[132:135], v[28:31], a[140:143]
    s_waitcnt lgkmcnt(0)
    s_waitcnt vmcnt(4)
    v_mfma_f32_16x16x32_bf16 a[0:3], v[64:67], v[32:35], a[0:3]
    ds_read_b64_tr_b16 v[100:101], v147 offset:27648
    v_mfma_f32_16x16x32_bf16 a[4:7], v[64:67], v[36:39], a[4:7]
    v_mfma_f32_16x16x32_bf16 a[8:11], v[64:67], v[40:43], a[8:11]
    ds_read_b64_tr_b16 v[102:103], v147 offset:28800
    v_mfma_f32_16x16x32_bf16 a[12:15], v[64:67], v[44:47], a[12:15]
    v_mfma_f32_16x16x32_bf16 a[16:19], v[68:71], v[32:35], a[16:19]
    ds_read_b64_tr_b16 v[104:105], v147 offset:27680
    v_mfma_f32_16x16x32_bf16 a[20:23], v[68:71], v[36:39], a[20:23]
    v_mfma_f32_16x16x32_bf16 a[24:27], v[68:71], v[40:43], a[24:27]
    ds_read_b64_tr_b16 v[106:107], v147 offset:28832
    v_mfma_f32_16x16x32_bf16 a[28:31], v[68:71], v[44:47], a[28:31]
    v_mfma_f32_16x16x32_bf16 a[32:35], v[72:75], v[32:35], a[32:35]
    ds_read_b64_tr_b16 v[108:109], v147 offset:27712
    v_mfma_f32_16x16x32_bf16 a[36:39], v[72:75], v[36:39], a[36:39]
    v_mfma_f32_16x16x32_bf16 a[40:43], v[72:75], v[40:43], a[40:43]
    ds_read_b64_tr_b16 v[110:111], v147 offset:28864
    v_mfma_f32_16x16x32_bf16 a[44:47], v[72:75], v[44:47], a[44:47]
    v_mfma_f32_16x16x32_bf16 a[48:51], v[76:79], v[32:35], a[48:51]
    ds_read_b64_tr_b16 v[112:113], v147 offset:27744
    v_mfma_f32_16x16x32_bf16 a[52:55], v[76:79], v[36:39], a[52:55]
    v_mfma_f32_16x16x32_bf16 a[56:59], v[76:79], v[40:43], a[56:59]
    ds_read_b64_tr_b16 v[114:115], v147 offset:28896
    v_mfma_f32_16x16x32_bf16 a[60:63], v[76:79], v[44:47], a[60:63]
    v_mfma_f32_16x16x32_bf16 a[64:67], v[80:83], v[32:35], a[64:67]
    ds_read_b64_tr_b16 v[116:117], v147 offset:27776
    v_mfma_f32_16x16x32_bf16 a[68:71], v[80:83], v[36:39], a[68:71]
    v_mfma_f32_16x16x32_bf16 a[72:75], v[80:83], v[40:43], a[72:75]
    ds_read_b64_tr_b16 v[118:119], v147 offset:28928
    v_mfma_f32_16x16x32_bf16 a[76:79], v[80:83], v[44:47], a[76:79]
    v_mfma_f32_16x16x32_bf16 a[80:83], v[84:87], v[32:35], a[80:83]
    ds_read_b64_tr_b16 v[120:121], v147 offset:27808
    v_mfma_f32_16x16x32_bf16 a[84:87], v[84:87], v[36:39], a[84:87]
    v_mfma_f32_16x16x32_bf16 a[88:91], v[84:87], v[40:43], a[88:91]
    ds_read_b64_tr_b16 v[122:123], v147 offset:28960
    v_mfma_f32_16x16x32_bf16 a[92:95], v[84:87], v[44:47], a[92:95]
    v_mfma_f32_16x16x32_bf16 a[96:99], v[88:91], v[32:35], a[96:99]
    ds_read_b64_tr_b16 v[124:125], v147 offset:27840
    v_mfma_f32_16x16x32_bf16 a[100:103], v[88:91], v[36:39], a[100:103]
    v_mfma_f32_16x16x32_bf16 a[104:107], v[88:91], v[40:43], a[104:107]
    ds_read_b64_tr_b16 v[126:127], v147 offset:28992
    v_mfma_f32_16x16x32_bf16 a[108:111], v[88:91], v[44:47], a[108:111]
    v_mfma_f32_16x16x32_bf16 a[112:115], v[92:95], v[32:35], a[112:115]
    ds_read_b64_tr_b16 v[128:129], v147 offset:27872
    v_mfma_f32_16x16x32_bf16 a[116:119], v[92:95], v[36:39], a[116:119]
    v_mfma_f32_16x16x32_bf16 a[120:123], v[92:95], v[40:43], a[120:123]
    s_waitcnt lgkmcnt(13)
    ds_read_b64_tr_b16 v[130:131], v147 offset:29024
    v_mfma_f32_16x16x32_bf16 a[124:127], v[92:95], v[44:47], a[124:127]
    v_mfma_f32_16x16x32_bf16 a[128:131], v[96:99], v[32:35], a[128:131]
    ds_read_b64_tr_b16 v[132:133], v147 offset:27904
    v_mfma_f32_16x16x32_bf16 a[132:135], v[96:99], v[36:39], a[132:135]
    v_mfma_f32_16x16x32_bf16 a[136:139], v[96:99], v[40:43], a[136:139]
    s_waitcnt lgkmcnt(13)
    ds_read_b64_tr_b16 v[134:135], v147 offset:29056
    v_mfma_f32_16x16x32_bf16 a[140:143], v[96:99], v[44:47], a[140:143]
    s_waitcnt lgkmcnt(0)
    s_waitcnt vmcnt(0)
    v_mfma_f32_16x16x32_bf16 a[0:3], v[100:103], v[48:51], a[0:3]
    v_mfma_f32_16x16x32_bf16 a[4:7], v[100:103], v[52:55], a[4:7]
    v_mfma_f32_16x16x32_bf16 a[8:11], v[100:103], v[56:59], a[8:11]
    v_mfma_f32_16x16x32_bf16 a[12:15], v[100:103], v[60:63], a[12:15]
    v_mfma_f32_16x16x32_bf16 a[16:19], v[104:107], v[48:51], a[16:19]
    v_mfma_f32_16x16x32_bf16 a[20:23], v[104:107], v[52:55], a[20:23]
    v_mfma_f32_16x16x32_bf16 a[24:27], v[104:107], v[56:59], a[24:27]
    v_mfma_f32_16x16x32_bf16 a[28:31], v[104:107], v[60:63], a[28:31]
    v_mfma_f32_16x16x32_bf16 a[32:35], v[108:111], v[48:51], a[32:35]
    v_mfma_f32_16x16x32_bf16 a[36:39], v[108:111], v[52:55], a[36:39]
    v_mfma_f32_16x16x32_bf16 a[40:43], v[108:111], v[56:59], a[40:43]
    v_mfma_f32_16x16x32_bf16 a[44:47], v[108:111], v[60:63], a[44:47]
    v_mfma_f32_16x16x32_bf16 a[48:51], v[112:115], v[48:51], a[48:51]
    v_mfma_f32_16x16x32_bf16 a[52:55], v[112:115], v[52:55], a[52:55]
    v_mfma_f32_16x16x32_bf16 a[56:59], v[112:115], v[56:59], a[56:59]
    v_mfma_f32_16x16x32_bf16 a[60:63], v[112:115], v[60:63], a[60:63]
    v_mfma_f32_16x16x32_bf16 a[64:67], v[116:119], v[48:51], a[64:67]
    v_mfma_f32_16x16x32_bf16 a[68:71], v[116:119], v[52:55], a[68:71]
    v_mfma_f32_16x16x32_bf16 a[72:75], v[116:119], v[56:59], a[72:75]
    v_mfma_f32_16x16x32_bf16 a[76:79], v[116:119], v[60:63], a[76:79]
    v_mfma_f32_16x16x32_bf16 a[80:83], v[120:123], v[48:51], a[80:83]
    v_mfma_f32_16x16x32_bf16 a[84:87], v[120:123], v[52:55], a[84:87]
    v_mfma_f32_16x16x32_bf16 a[88:91], v[120:123], v[56:59], a[88:91]
    v_mfma_f32_16x16x32_bf16 a[92:95], v[120:123], v[60:63], a[92:95]
    v_mfma_f32_16x16x32_bf16 a[96:99], v[124:127], v[48:51], a[96:99]
    v_mfma_f32_16x16x32_bf16 a[100:103], v[124:127], v[52:55], a[100:103]
    v_mfma_f32_16x16x32_bf16 a[104:107], v[124:127], v[56:59], a[104:107]
    v_mfma_f32_16x16x32_bf16 a[108:111], v[124:127], v[60:63], a[108:111]
    v_mfma_f32_16x16x32_bf16 a[112:115], v[128:131], v[48:51], a[112:115]
    v_mfma_f32_16x16x32_bf16 a[116:119], v[128:131], v[52:55], a[116:119]
    v_mfma_f32_16x16x32_bf16 a[120:123], v[128:131], v[56:59], a[120:123]
    v_mfma_f32_16x16x32_bf16 a[124:127], v[128:131], v[60:63], a[124:127]
    v_mfma_f32_16x16x32_bf16 a[128:131], v[132:135], v[48:51], a[128:131]
    v_mfma_f32_16x16x32_bf16 a[132:135], v[132:135], v[52:55], a[132:135]
    v_mfma_f32_16x16x32_bf16 a[136:139], v[132:135], v[56:59], a[136:139]
    v_mfma_f32_16x16x32_bf16 a[140:143], v[132:135], v[60:63], a[140:143]
    v_lshlrev_b32 v150, 4, v149
    v_add_u32 v151, s24, v150
    s_nop 7
    ds_write_b128 v151, a[0:3] offset:0
    ds_write_b128 v151, a[4:7] offset:1024
    ds_write_b128 v151, a[8:11] offset:2048
    ds_write_b128 v151, a[12:15] offset:3072
    ds_write_b128 v151, a[16:19] offset:4096
    ds_write_b128 v151, a[20:23] offset:5120
    ds_write_b128 v151, a[24:27] offset:6144
    ds_write_b128 v151, a[28:31] offset:7168
    ds_write_b128 v151, a[32:35] offset:8192
    ds_write_b128 v151, a[36:39] offset:9216
    ds_write_b128 v151, a[40:43] offset:10240
    ds_write_b128 v151, a[44:47] offset:11264
    ds_write_b128 v151, a[48:51] offset:12288
    ds_write_b128 v151, a[52:55] offset:13312
    s_waitcnt lgkmcnt(0)
    ds_write_b128 v151, a[56:59] offset:14336
    ds_write_b128 v151, a[60:63] offset:15360
    ds_write_b128 v151, a[64:67] offset:16384
    ds_write_b128 v151, a[68:71] offset:17408
    ds_write_b128 v151, a[72:75] offset:18432
    ds_write_b128 v151, a[76:79] offset:19456
    ds_write_b128 v151, a[80:83] offset:20480
    ds_write_b128 v151, a[84:87] offset:21504
    ds_write_b128 v151, a[88:91] offset:22528
    ds_write_b128 v151, a[92:95] offset:23552
    ds_write_b128 v151, a[96:99] offset:24576
    ds_write_b128 v151, a[100:103] offset:25600
    ds_write_b128 v151, a[104:107] offset:26624
    ds_write_b128 v151, a[108:111] offset:27648
    s_waitcnt lgkmcnt(0)
    ds_write_b128 v151, a[112:115] offset:28672
    ds_write_b128 v151, a[116:119] offset:29696
    ds_write_b128 v151, a[120:123] offset:30720
    ds_write_b128 v151, a[124:127] offset:31744
    ds_write_b128 v151, a[128:131] offset:32768
    ds_write_b128 v151, a[132:135] offset:33792
    ds_write_b128 v151, a[136:139] offset:34816
    ds_write_b128 v151, a[140:143] offset:35840
    s_waitcnt lgkmcnt(0)
    s_barrier
    s_lshl_b32 s63, s28, 10
    v_add_u32 v150, s63, v150
    v_add_u32 v151, 36864, v150
    v_add_u32 v152, 73728, v150
    v_add_u32 v153, 110592, v150
    s_and_b32 s63, s60, 31
    s_lshl_b32 s63, s63, 6
    s_lshl_b32 s64, s28, 4
    s_add_u32 s63, s63, s64
    v_and_b32 v147, 15, v149
    v_add_u32 v147, s63, v147
    v_mul_u32_u24 v147, 2304, v147
    v_lshrrev_b32 v138, 4, v149
    v_lshl_add_u32 v147, v138, 3, v147
    s_mul_i32 s63, s61, 1152
    s_mul_i32 s64, s62, 288
    s_add_u32 s63, s63, s64
    v_add_u32 v147, s63, v147
    ds_read_b128 v[0:3], v150 offset:0
    ds_read_b128 v[4:7], v151 offset:0
    ds_read_b128 v[8:11], v152 offset:0
    ds_read_b128 v[12:15], v153 offset:0
    ds_read_b128 v[16:19], v150 offset:4096
    ds_read_b128 v[20:23], v151 offset:4096
    ds_read_b128 v[24:27], v152 offset:4096
    ds_read_b128 v[28:31], v153 offset:4096
    ds_read_b128 v[32:35], v150 offset:8192
    ds_read_b128 v[36:39], v151 offset:8192
    ds_read_b128 v[40:43], v152 offset:8192
    ds_read_b128 v[44:47], v153 offset:8192
    s_waitcnt lgkmcnt(10)
    v_add_f32 v0, v0, v4
    s_waitcnt lgkmcnt(8)
    v_add_f32 v8, v8, v12
    v_add_f32 v1, v1, v5
    v_add_f32 v9, v9, v13
    v_add_f32 v2, v2, v6
    v_add_f32 v10, v10, v14
    v_add_f32 v3, v3, v7
    v_add_f32 v11, v11, v15
    v_add_f32 v0, v0, v8
    v_add_f32 v1, v1, v9
    v_add_f32 v2, v2, v10
    v_add_f32 v3, v3, v11
    v_cvt_pk_bf16_f32 v64, v0, v1
    v_cvt_pk_bf16_f32 v65, v2, v3
    buffer_store_dwordx2 v[64:65], v147, s[12:15], 0 offen
    s_waitcnt lgkmcnt(6)
    v_add_f32 v16, v16, v20
    s_waitcnt lgkmcnt(4)
    v_add_f32 v24, v24, v28
    v_add_f32 v17, v17, v21
    v_add_f32 v25, v25, v29
    v_add_f32 v18, v18, v22
    v_add_f32 v26, v26, v30
    v_add_f32 v19, v19, v23
    v_add_f32 v27, v27, v31
    v_add_f32 v16, v16, v24
    v_add_f32 v17, v17, v25
    v_add_f32 v18, v18, v26
    v_add_f32 v19, v19, v27
    v_cvt_pk_bf16_f32 v66, v16, v17
    v_cvt_pk_bf16_f32 v67, v18, v19
    buffer_store_dwordx2 v[66:67], v147, s[12:15], 0 offen offset:32
    s_waitcnt lgkmcnt(2)
    v_add_f32 v32, v32, v36
    s_waitcnt lgkmcnt(0)
    v_add_f32 v40, v40, v44
    v_add_f32 v33, v33, v37
    v_add_f32 v41, v41, v45
    v_add_f32 v34, v34, v38
    v_add_f32 v42, v42, v46
    v_add_f32 v35, v35, v39
    v_add_f32 v43, v43, v47
    v_add_f32 v32, v32, v40
    v_add_f32 v33, v33, v41
    v_add_f32 v34, v34, v42
    v_add_f32 v35, v35, v43
    v_cvt_pk_bf16_f32 v68, v32, v33
    v_cvt_pk_bf16_f32 v69, v34, v35
    buffer_store_dwordx2 v[68:69], v147, s[12:15], 0 offen offset:64
    ds_read_b128 v[0:3], v150 offset:12288
    ds_read_b128 v[4:7], v151 offset:12288
    ds_read_b128 v[8:11], v152 offset:12288
    ds_read_b128 v[12:15], v153 offset:12288
    ds_read_b128 v[16:19], v150 offset:16384
    ds_read_b128 v[20:23], v151 offset:16384
    ds_read_b128 v[24:27], v152 offset:16384
    ds_read_b128 v[28:31], v153 offset:16384
    ds_read_b128 v[32:35], v150 offset:20480
    ds_read_b128 v[36:39], v151 offset:20480
    ds_read_b128 v[40:43], v152 offset:20480
    ds_read_b128 v[44:47], v153 offset:20480
    s_waitcnt lgkmcnt(10)
    v_add_f32 v0, v0, v4
    s_waitcnt lgkmcnt(8)
    v_add_f32 v8, v8, v12
    v_add_f32 v1, v1, v5
    v_add_f32 v9, v9, v13
    v_add_f32 v2, v2, v6
    v_add_f32 v10, v10, v14
    v_add_f32 v3, v3, v7
    v_add_f32 v11, v11, v15
    v_add_f32 v0, v0, v8
    v_add_f32 v1, v1, v9
    v_add_f32 v2, v2, v10
    v_add_f32 v3, v3, v11
    v_cvt_pk_bf16_f32 v70, v0, v1
    v_cvt_pk_bf16_f32 v71, v2, v3
    buffer_store_dwordx2 v[70:71], v147, s[12:15], 0 offen offset:96
    s_waitcnt lgkmcnt(6)
    v_add_f32 v16, v16, v20
    s_waitcnt lgkmcnt(4)
    v_add_f32 v24, v24, v28
    v_add_f32 v17, v17, v21
    v_add_f32 v25, v25, v29
    v_add_f32 v18, v18, v22
    v_add_f32 v26, v26, v30
    v_add_f32 v19, v19, v23
    v_add_f32 v27, v27, v31
    v_add_f32 v16, v16, v24
    v_add_f32 v17, v17, v25
    v_add_f32 v18, v18, v26
    v_add_f32 v19, v19, v27
    v_cvt_pk_bf16_f32 v72, v16, v17
    v_cvt_pk_bf16_f32 v73, v18, v19
    buffer_store_dwordx2 v[72:73], v147, s[12:15], 0 offen offset:128
    s_waitcnt lgkmcnt(2)
    v_add_f32 v32, v32, v36
    s_waitcnt lgkmcnt(0)
    v_add_f32 v40, v40, v44
    v_add_f32 v33, v33, v37
    v_add_f32 v41, v41, v45
    v_add_f32 v34, v34, v38
    v_add_f32 v42, v42, v46
    v_add_f32 v35, v35, v39
    v_add_f32 v43, v43, v47
    v_add_f32 v32, v32, v40
    v_add_f32 v33, v33, v41
    v_add_f32 v34, v34, v42
    v_add_f32 v35, v35, v43
    v_cvt_pk_bf16_f32 v74, v32, v33
    v_cvt_pk_bf16_f32 v75, v34, v35
    buffer_store_dwordx2 v[74:75], v147, s[12:15], 0 offen offset:160
    ds_read_b128 v[0:3], v150 offset:24576
    ds_read_b128 v[4:7], v151 offset:24576
    ds_read_b128 v[8:11], v152 offset:24576
    ds_read_b128 v[12:15], v153 offset:24576
    ds_read_b128 v[16:19], v150 offset:28672
    ds_read_b128 v[20:23], v151 offset:28672
    ds_read_b128 v[24:27], v152 offset:28672
    ds_read_b128 v[28:31], v153 offset:28672
    ds_read_b128 v[32:35], v150 offset:32768
    ds_read_b128 v[36:39], v151 offset:32768
    ds_read_b128 v[40:43], v152 offset:32768
    ds_read_b128 v[44:47], v153 offset:32768
    s_waitcnt lgkmcnt(10)
    v_add_f32 v0, v0, v4
    s_waitcnt lgkmcnt(8)
    v_add_f32 v8, v8, v12
    v_add_f32 v1, v1, v5
    v_add_f32 v9, v9, v13
    v_add_f32 v2, v2, v6
    v_add_f32 v10, v10, v14
    v_add_f32 v3, v3, v7
    v_add_f32 v11, v11, v15
    v_add_f32 v0, v0, v8
    v_add_f32 v1, v1, v9
    v_add_f32 v2, v2, v10
    v_add_f32 v3, v3, v11
    v_cvt_pk_bf16_f32 v76, v0, v1
    v_cvt_pk_bf16_f32 v77, v2, v3
    buffer_store_dwordx2 v[76:77], v147, s[12:15], 0 offen offset:192
    s_waitcnt lgkmcnt(6)
    v_add_f32 v16, v16, v20
    s_waitcnt lgkmcnt(4)
    v_add_f32 v24, v24, v28
    v_add_f32 v17, v17, v21
    v_add_f32 v25, v25, v29
    v_add_f32 v18, v18, v22
    v_add_f32 v26, v26, v30
    v_add_f32 v19, v19, v23
    v_add_f32 v27, v27, v31
    v_add_f32 v16, v16, v24
    v_add_f32 v17, v17, v25
    v_add_f32 v18, v18, v26
    v_add_f32 v19, v19, v27
    v_cvt_pk_bf16_f32 v78, v16, v17
    v_cvt_pk_bf16_f32 v79, v18, v19
    buffer_store_dwordx2 v[78:79], v147, s[12:15], 0 offen offset:224
    s_waitcnt lgkmcnt(2)
    v_add_f32 v32, v32, v36
    s_waitcnt lgkmcnt(0)
    v_add_f32 v40, v40, v44
    v_add_f32 v33, v33, v37
    v_add_f32 v41, v41, v45
    v_add_f32 v34, v34, v38
    v_add_f32 v42, v42, v46
    v_add_f32 v35, v35, v39
    v_add_f32 v43, v43, v47
    v_add_f32 v32, v32, v40
    v_add_f32 v33, v33, v41
    v_add_f32 v34, v34, v42
    v_add_f32 v35, v35, v43
    v_cvt_pk_bf16_f32 v80, v32, v33
    v_cvt_pk_bf16_f32 v81, v34, v35
    buffer_store_dwordx2 v[80:81], v147, s[12:15], 0 offen offset:256
L2_exit:
    s_endpgm
.section .rodata,"a"
.p2align 6
.amdhsa_kernel concat_heads__gqa_block_cached__gqa_block_cached__near_ridge_kernel
  .amdhsa_next_free_vgpr 256
  .amdhsa_next_free_sgpr 100
  .amdhsa_accum_offset 256
  .amdhsa_group_segment_fixed_size 0
  .amdhsa_kernarg_size 104
  .amdhsa_user_sgpr_count 2
  .amdhsa_user_sgpr_kernarg_segment_ptr 1
  .amdhsa_system_sgpr_workgroup_id_x 1
.end_amdhsa_kernel
.p2align 6
.amdhsa_kernel concat_oproj_kernel
  .amdhsa_next_free_vgpr 300
  .amdhsa_next_free_sgpr 80
  .amdhsa_accum_offset 156
  .amdhsa_group_segment_fixed_size 0
  .amdhsa_kernarg_size 104
  .amdhsa_user_sgpr_count 2
  .amdhsa_user_sgpr_kernarg_segment_ptr 1
  .amdhsa_system_sgpr_workgroup_id_x 1
.end_amdhsa_kernel
```
